```python
import torch

def _softmax(x, axis=-1):
    return torch.softmax(x, dim=axis)
def _gelu(x):
    return torch.nn.functional.gelu(x, approximate="tanh")
def _silu(x):
    return torch.nn.functional.silu(x)
def _sigmoid(x):
    return torch.sigmoid(x)
def _layernorm(x, axis=-1, eps=1e-5):
    m = x.mean(dim=axis, keepdim=True)
    v = x.var(dim=axis, keepdim=True, unbiased=False)
    return (x - m) / torch.sqrt(v + eps)
def _scatter_add(tgt, idx, src, axis=0):
    return tgt.clone().index_add_(axis, idx, src)
def _segment_sum(src, seg, n):
    out = torch.zeros((n,) + src.shape[1:], dtype=src.dtype)
    return out.index_add_(0, seg, src)
def _pad(x, pw):
    flat = tuple(v for pair in reversed(pw) for v in pair)
    return torch.nn.functional.pad(x, flat)

kernel_name = 'sequential_preLN__sliding_block__mixer_token_mlp__prompt'

def setup_inputs():

    _w = (lambda a: (lambda t: t.to(torch.bfloat16) if t.is_floating_point() else t)(torch.as_tensor(a)))
    def _A_setup():
        B, S, D = 1, 2048, 512
        return {
            "x": _w((lambda *s: torch.randn(*s, dtype=torch.bfloat16) * 0.05)(B, S, D)),
            "wqkv": _w((lambda *s: torch.randn(*s, dtype=torch.bfloat16) * 0.05)(D, 3 * D)),
            "wo": _w((lambda *s: torch.randn(*s, dtype=torch.bfloat16) * 0.05)(D, D)),
        }
    _A_in = _A_setup()

    def _B_setup():
        B, S, D, F = 1, 2048, 512, 1376
        return {
            "x": _w((lambda *s: torch.randn(*s, dtype=torch.bfloat16) * 0.05)(B, S, D)),
            "w1": _w((lambda *s: torch.randn(*s, dtype=torch.bfloat16) * 0.8)(S, F) * (S ** -0.5)),
            "b1": _w((lambda *s: torch.randn(*s, dtype=torch.bfloat16) * 0.8)(F) * 0.02),
            "w2": _w((lambda *s: torch.randn(*s, dtype=torch.bfloat16) * 0.8)(F, S) * (F ** -0.5)),
            "b2": _w((lambda *s: torch.randn(*s, dtype=torch.bfloat16) * 0.8)(S) * 0.02),
        }
    _B_in = _B_setup()

    return {
        "A_x": _A_in["x"],
        "A_wqkv": _A_in["wqkv"],
        "A_wo": _A_in["wo"],
        "B_x": _B_in["x"],
        "B_w1": _B_in["w1"],
        "B_b1": _B_in["b1"],
        "B_w2": _B_in["w2"],
        "B_b2": _B_in["b2"],
    }

def reference(A_x, A_wqkv, A_wo, B_x, B_w1, B_b1, B_w2, B_b2):
    def _A_ref(x, wqkv, wo):
        B, S, D = x.shape
        H = 32; Dh = D // H; W = 256
        qkv = (lambda x, *d: x.permute(*d))((x @ wqkv).reshape(B, S, 3, H, Dh), 2, 0, 3, 1, 4)
        q, k, v = qkv[0], qkv[1], qkv[2]
        scores = torch.einsum("bhqd,bhkd->bhqk", q, k) * (Dh ** -0.5)
        idx = torch.arange(S)
        mask = (idx[:, None] - idx[None, :] >= 0) & (idx[:, None] - idx[None, :] < W)
        scores = torch.where(mask[None, None], scores, -1e9)
        p = _softmax(scores, axis=-1)
        o = torch.einsum("bhqk,bhkd->bhqd", p, v)
        return (lambda x, *d: x.permute(*d))(o, 0, 2, 1, 3).reshape(B, S, D) @ wo

    def _B_ref(x, w1, b1, w2, b2):
        B, S, D = x.shape
        h = _layernorm(x, axis=-1)
        u = torch.einsum("bsd,sf->bdf", h, w1) + b1
        u = _gelu(u)
        y = torch.einsum("bdf,fs->bds", u, w2) + b2
        return (lambda x, *d: x.permute(*d))(y, 0, 2, 1)

    x = A_x
    h = x + _A_ref(_layernorm(x, axis=-1), A_wqkv, A_wo)
    h2 = h + _B_ref(_layernorm(h, axis=-1), B_w1, B_b1, B_w2, B_b2)
    return h2
```

```asm
; @launch grid=(256,1,1) block=(512,1,1) lds=163840
.amdgcn_target "amdgcn-amd-amdhsa--gfx950"
.text
.globl sequential_preLN__sliding_block__mixer_token_mlp__prompt_kernel
.p2align 8
.type sequential_preLN__sliding_block__mixer_token_mlp__prompt_kernel,@function
sequential_preLN__sliding_block__mixer_token_mlp__prompt_kernel:
    s_cmp_ge_u32 s2, 256
    s_cbranch_scc1 Lend
    s_load_dwordx2 s[8:9], s[0:1], 0
    s_load_dwordx2 s[12:13], s[0:1], 8
    s_getpc_b64 s[52:53]
Lpc:
    s_lshr_b32 s50, s2, 3
    s_lshl_b32 s50, s50, 10
    v_lshl_add_u32 v5, v0, 1, s50
    v_min_u32 v5, Lcodeend-Lpc-4, v5
    s_mov_b64 exec, 1
    global_load_dword v23, v5, s[52:53]
    s_mov_b64 exec, -1
    v_and_b32 v3, 63, v0
    v_lshrrev_b32 v5, 6, v0
    v_lshlrev_b32 v1, 4, v3
    v_readfirstlane_b32 s5, v5
    s_mov_b32 s10, 2097152
    s_mov_b32 s11, 0x20000
    s_mov_b32 s14, 1572864
    s_mov_b32 s15, 0x20000
    s_bfe_u32 s52, s2, 0x20001
    s_and_b32 s53, s2, 1
    s_bfe_u32 s54, s2, 0x30003
    s_lshr_b32 s55, s2, 6
    s_xor_b32 s55, s55, 3
    s_lshl_b32 s46, s52, 3
    s_add_u32 s46, s46, s54
    s_lshl_b32 s47, s53, 2
    s_add_u32 s47, s47, s55
    s_lshl_b32 s60, s55, 1
    s_add_u32 s60, s60, s54
    s_add_u32 s60, s60, s53
    s_and_b32 s4, s60, 1
    s_cmp_eq_u32 s47, 3
    s_cselect_b32 s4, 0, s4
    s_cselect_b32 s50, 7, 6
    s_and_b32 s60, s60, s50
    s_and_b32 s45, s5, 3
    v_bfe_u32 v5, v3, 4, 1
    v_lshlrev_b32 v5, 6, v5
    v_and_b32 v253, 0x70, v1
    v_xor_b32 v253, v253, v5
    s_cmp_lt_u32 s5, 4
    s_cbranch_scc1 LA
    v_lshrrev_b32 v5, 3, v3
    v_and_b32 v6, 7, v3
    v_lshrrev_b32 v7, 1, v5
    s_lshl_b32 s50, s45, 4
    v_add_u32 v5, s50, v5
    v_xor_b32 v8, v6, v7
    v_lshlrev_b32 v8, 4, v8
    v_lshl_add_u32 v8, v5, 10, v8
    v_xor_b32 v9, 64, v8
    v_add_u32 v9, 8192, v9
    v_mul_u32_u24 v10, 3072, v5
    v_add_u32 v10, v10, v253
    s_lshl_b32 s57, s45, 11
    s_lshl_b32 s55, s46, 16
    s_lshl_b32 s56, s47, 7
    s_mov_b32 s64, s60
    s_mov_b32 s65, s57
    s_lshl_b32 s66, s64, 7
    s_add_u32 s66, s66, s55
    s_waitcnt lgkmcnt(0)
    s_add_u32 m0, s65, 0
    s_mul_i32 s67, s64, 196608
    s_add_u32 s64, s64, 1
    buffer_load_dwordx4 v8, s[8:11], s66 offen lds
    s_add_u32 m0, s65, 1024
    s_add_u32 s67, s67, s56
    s_and_b32 s64, s64, 7
    buffer_load_dwordx4 v9, s[8:11], s66 offen lds
    s_add_u32 m0, s65, 7168
    s_add_u32 s71, s67, 24576
    s_lshl_b32 s66, s64, 7
    buffer_load_dwordx4 v10, s[12:15], s67 offen offset:1024 lds
    s_add_u32 m0, s65, 8192
    s_add_u32 s66, s66, s55
    buffer_load_dwordx4 v10, s[12:15], s71 offen offset:1024 lds
    s_add_u32 m0, s65, 14336
    s_add_u32 s3, s3, 1
    buffer_load_dwordx4 v10, s[12:15], s67 offen offset:2048 lds
    s_add_u32 m0, s65, 15360
    s_add_u32 s65, s65, 24576
    s_cmp_ge_u32 s65, 73728
    s_cselect_b32 s65, s57, s65
    s_cmp_lt_u32 s3, 6
    buffer_load_dwordx4 v10, s[12:15], s71 offen offset:2048 lds
    s_add_u32 m0, s65, 0
    s_mul_i32 s67, s64, 196608
    s_add_u32 s64, s64, 1
    buffer_load_dwordx4 v8, s[8:11], s66 offen lds
    s_add_u32 m0, s65, 1024
    s_add_u32 s67, s67, s56
    s_and_b32 s64, s64, 7
    buffer_load_dwordx4 v9, s[8:11], s66 offen lds
    s_add_u32 m0, s65, 7168
    s_add_u32 s71, s67, 24576
    s_lshl_b32 s66, s64, 7
    buffer_load_dwordx4 v10, s[12:15], s67 offen offset:1024 lds
    s_add_u32 m0, s65, 8192
    s_add_u32 s66, s66, s55
    buffer_load_dwordx4 v10, s[12:15], s71 offen offset:1024 lds
    s_add_u32 m0, s65, 14336
    s_add_u32 s3, s3, 1
    buffer_load_dwordx4 v10, s[12:15], s67 offen offset:2048 lds
    s_add_u32 m0, s65, 15360
    s_add_u32 s65, s65, 24576
    s_cmp_ge_u32 s65, 73728
    s_cselect_b32 s65, s57, s65
    s_cmp_lt_u32 s3, 6
    buffer_load_dwordx4 v10, s[12:15], s71 offen offset:2048 lds
    s_mul_i32 s67, s60, 196608
    s_add_u32 s67, s67, s56
    s_add_u32 m0, s57, 98304
    s_nop 0
    buffer_load_dwordx4 v10, s[12:15], s67 offen lds
    s_add_u32 m0, s57, 99328
    s_add_u32 s67, s67, 24576
    buffer_load_dwordx4 v10, s[12:15], s67 offen lds
    s_load_dwordx2 s[32:33], s[0:1], 80
    s_load_dwordx2 s[16:17], s[0:1], 16
    s_load_dwordx2 s[20:21], s[0:1], 32
    s_load_dwordx2 s[36:37], s[0:1], 40
    s_load_dwordx2 s[24:25], s[0:1], 48
    s_load_dwordx2 s[40:41], s[0:1], 56
    s_load_dwordx2 s[28:29], s[0:1], 64
    s_mov_b32 s18, 524288
    s_mov_b32 s19, 0x20000
    s_mov_b32 s22, 5636096
    s_mov_b32 s23, 0x20000
    s_mov_b32 s38, 2752
    s_mov_b32 s39, 0x20000
    s_mov_b32 s26, 5636096
    s_mov_b32 s27, 0x20000
    s_mov_b32 s42, 4096
    s_mov_b32 s43, 0x20000
    s_mov_b32 s30, 2097152
    s_mov_b32 s31, 0x20000
    s_mov_b32 s34, 18874368
    s_mov_b32 s35, 0x20000
    v_lshlrev_b32 v4, 2, v3
    s_bfe_u32 s50, s2, 0x20001
    s_bfe_u32 s51, s2, 0x20003
    s_lshl_b32 s48, s50, 2
    s_add_u32 s48, s48, s51
    s_lshr_b32 s51, s2, 5
    s_and_b32 s49, s2, 1
    s_lshl_b32 s49, s49, 3
    s_add_u32 s49, s49, s51
    s_and_b32 s58, s45, 1
    s_lshr_b32 s59, s45, 1
    s_waitcnt lgkmcnt(0)
    s_load_dword s44, s[32:33], 0
    v_bfe_u32 v5, v3, 2, 2
    v_bfe_u32 v6, v3, 4, 1
    v_lshlrev_b32 v6, 5, v6
    v_and_b32 v7, 3, v3
    v_lshl_add_u32 v6, v7, 3, v6
    v_lshl_add_u32 v248, v5, 7, v6
    v_lshl_add_u32 v249, v5, 6, v6
    v_lshrrev_b32 v5, 1, v5
    v_lshl_add_u32 v248, v5, 6, v248
    v_lshrrev_b32 v5, 5, v3
    v_lshl_add_u32 v249, v5, 9, v249
    v_and_b32 v6, 31, v3
    v_lshlrev_b32 v5, 3, v5
    v_lshl_add_u32 v250, v6, 6, v5
    v_mov_b32 v251, 73728
    v_mov_b32 v252, 1
    s_lshl_b32 s62, s46, 1
    s_add_u32 s62, s62, s58
    s_lshl_b32 s63, s62, 3
    s_add_u32 s63, s63, s47
    s_lshl_b32 s63, s63, 1
    s_add_u32 s63, s63, s59
    s_lshl_b32 s7, s46, 3
    s_add_u32 s7, s7, s47
    s_lshl_b32 s7, s7, 8
    s_lshl_b32 s98, s48, 4
    s_add_u32 s98, s98, s49
    s_lshl_b32 s98, s98, 8
    s_mul_i32 s6, s59, 2818048
    s_lshl_b32 s50, s58, 15
    s_add_u32 s6, s6, s50
    s_lshl_b32 s50, s46, 7
    s_add_u32 s6, s6, s50
    v_lshrrev_b32 v5, 2, v3
    v_mul_u32_u24 v14, 2752, v5
    v_and_b32 v6, 3, v3
    v_lshl_add_u32 v14, v6, 4, v14
    v_lshlrev_b32 v6, 7, v6
    v_lshl_add_u32 v13, v5, 10, v6
    v_lshrrev_b32 v5, 3, v3
    v_lshl_add_u32 v15, v5, 10, v253
    v_lshl_add_u32 v247, v5, 12, v253
    s_lshl_b32 s68, s49, 2
    s_add_u32 s68, s68, s45
    s_mul_i32 s69, s45, 6144
    s_add_u32 s69, s69, 49152
    s_lshl_b32 s70, s45, 17
    s_add_u32 s70, s70, s56
    s_mul_i32 s77, s68, 88064
    s_mul_i32 s52, s48, 192
    s_add_u32 s77, s77, s52
    s_mul_i32 s61, s48, 393216
    s_mul_i32 s52, s68, 6144
    s_add_u32 s61, s61, s52
    s_add_u32 s61, s61, 12582912
    s_lshl_b32 s4, s48, 12
    s_lshl_b32 s51, s49, 2
    s_add_u32 s4, s4, s51
    s_add_u32 s4, s4, 327680
    s_lshr_b32 s78, s2, 3
    s_lshl_b32 s78, s78, 2
    s_add_u32 s78, s78, s45
    s_lshl_b32 s78, s78, 12
    s_and_b32 s51, s2, 1
    s_lshl_b32 s51, s51, 9
    s_add_u32 s78, s78, s51
    v_lshrrev_b32 v12, 1, v3
    v_mul_u32_u24 v12, 4128, v12
    v_and_b32 v7, 1, v3
    v_mul_u32_u24 v7, 1040, v7
    v_add_u32 v12, v12, v7
    v_mov_b32 v16, 0x3f803f80
    v_mov_b32 v17, 0x3f803f80
    v_mov_b32 v18, 0x3f803f80
    v_mov_b32 v19, 0x3f803f80
    s_mov_b32 s3, 0
    s_waitcnt lgkmcnt(0)
    s_mul_i32 s0, s44, 1664525
    s_add_u32 s0, s0, 1013904223
    s_mov_b32 s1, s0
    v_mov_b32 v2, s0
    s_setprio 3
    s_mov_b64 exec, 0xffff
    buffer_load_dword v20, v13, s[16:19], s78 offen
    s_mov_b64 exec, -1
    s_waitcnt vmcnt(9)
    s_barrier
    s_add_u32 m0, s65, 0
    s_mul_i32 s67, s64, 196608
    s_add_u32 s64, s64, 1
    buffer_load_dwordx4 v8, s[8:11], s66 offen lds
    s_add_u32 m0, s65, 1024
    s_add_u32 s67, s67, s56
    s_and_b32 s64, s64, 7
    buffer_load_dwordx4 v9, s[8:11], s66 offen lds
    s_add_u32 m0, s65, 7168
    s_add_u32 s71, s67, 24576
    s_lshl_b32 s66, s64, 7
    buffer_load_dwordx4 v10, s[12:15], s67 offen offset:1024 lds
    s_add_u32 m0, s65, 8192
    s_add_u32 s66, s66, s55
    buffer_load_dwordx4 v10, s[12:15], s71 offen offset:1024 lds
    s_add_u32 m0, s65, 14336
    s_add_u32 s3, s3, 1
    buffer_load_dwordx4 v10, s[12:15], s67 offen offset:2048 lds
    s_add_u32 m0, s65, 15360
    s_add_u32 s65, s65, 24576
    s_cmp_ge_u32 s65, 73728
    s_cselect_b32 s65, s57, s65
    s_cmp_lt_u32 s3, 6
    buffer_load_dwordx4 v10, s[12:15], s71 offen offset:2048 lds
    s_waitcnt vmcnt(9)
    s_branch LB1b
LB1:
    s_waitcnt vmcnt(6)
LB1b:
    s_barrier
    s_add_u32 m0, s65, 0
    s_mul_i32 s67, s64, 196608
    s_add_u32 s64, s64, 1
    buffer_load_dwordx4 v8, s[8:11], s66 offen lds
    s_add_u32 m0, s65, 1024
    s_add_u32 s67, s67, s56
    s_and_b32 s64, s64, 7
    buffer_load_dwordx4 v9, s[8:11], s66 offen lds
    s_add_u32 m0, s65, 7168
    s_add_u32 s71, s67, 24576
    s_lshl_b32 s66, s64, 7
    buffer_load_dwordx4 v10, s[12:15], s67 offen offset:1024 lds
    s_add_u32 m0, s65, 8192
    s_add_u32 s66, s66, s55
    buffer_load_dwordx4 v10, s[12:15], s71 offen offset:1024 lds
    s_add_u32 m0, s65, 14336
    s_add_u32 s3, s3, 1
    buffer_load_dwordx4 v10, s[12:15], s67 offen offset:2048 lds
    s_add_u32 m0, s65, 15360
    s_add_u32 s65, s65, 24576
    s_cmp_ge_u32 s65, 73728
    s_cselect_b32 s65, s57, s65
    s_cmp_lt_u32 s3, 6
    buffer_load_dwordx4 v10, s[12:15], s71 offen offset:2048 lds
    s_cbranch_scc1 LB1
    s_add_u32 s64, s64, 1
    s_and_b32 s64, s64, 7
    s_waitcnt vmcnt(6)
    s_barrier
    s_add_u32 m0, s57, 106496
    s_mul_i32 s67, s64, 196608
    s_add_u32 s67, s67, s56
    buffer_load_dwordx4 v10, s[12:15], s67 offen lds
    s_add_u32 m0, s57, 107520
    s_add_u32 s67, s67, 24576
    s_add_u32 s64, s64, 1
    s_and_b32 s64, s64, 7
    buffer_load_dwordx4 v10, s[12:15], s67 offen lds
    s_add_u32 m0, s57, 114688
    s_mul_i32 s67, s64, 196608
    s_add_u32 s67, s67, s56
    buffer_load_dwordx4 v10, s[12:15], s67 offen lds
    s_add_u32 m0, s57, 115712
    s_add_u32 s67, s67, 24576
    s_add_u32 s64, s64, 1
    s_and_b32 s64, s64, 7
    buffer_load_dwordx4 v10, s[12:15], s67 offen lds
    s_add_u32 m0, s57, 122880
    s_mul_i32 s67, s64, 196608
    s_add_u32 s67, s67, s56
    buffer_load_dwordx4 v10, s[12:15], s67 offen lds
    s_add_u32 m0, s57, 123904
    s_add_u32 s67, s67, 24576
    s_add_u32 s64, s64, 1
    s_and_b32 s64, s64, 7
    buffer_load_dwordx4 v10, s[12:15], s67 offen lds
    s_waitcnt vmcnt(6)
    s_barrier
    s_add_u32 m0, s57, 131072
    s_mul_i32 s67, s64, 196608
    s_add_u32 s67, s67, s56
    buffer_load_dwordx4 v10, s[12:15], s67 offen lds
    s_add_u32 m0, s57, 132096
    s_add_u32 s67, s67, 24576
    s_add_u32 s64, s64, 1
    s_and_b32 s64, s64, 7
    buffer_load_dwordx4 v10, s[12:15], s67 offen lds
    s_add_u32 m0, s57, 139264
    s_mul_i32 s67, s64, 196608
    s_add_u32 s67, s67, s56
    buffer_load_dwordx4 v10, s[12:15], s67 offen lds
    s_add_u32 m0, s57, 140288
    s_add_u32 s67, s67, 24576
    s_add_u32 s64, s64, 1
    s_and_b32 s64, s64, 7
    buffer_load_dwordx4 v10, s[12:15], s67 offen lds
    s_add_u32 m0, s57, 147456
    s_mul_i32 s67, s64, 196608
    s_add_u32 s67, s67, s56
    buffer_load_dwordx4 v10, s[12:15], s67 offen lds
    s_add_u32 m0, s57, 148480
    s_add_u32 s67, s67, 24576
    s_add_u32 s64, s64, 1
    s_and_b32 s64, s64, 7
    buffer_load_dwordx4 v10, s[12:15], s67 offen lds
    s_add_u32 m0, s57, 155648
    s_mul_i32 s67, s64, 196608
    s_add_u32 s67, s67, s56
    buffer_load_dwordx4 v10, s[12:15], s67 offen lds
    s_add_u32 m0, s57, 156672
    s_add_u32 s67, s67, 24576
    s_add_u32 s64, s64, 1
    s_and_b32 s64, s64, 7
    buffer_load_dwordx4 v10, s[12:15], s67 offen lds
    s_waitcnt vmcnt(0)
    s_mov_b64 exec, 1
    ds_add_u32 v251, v252 offset:96
    s_mov_b64 exec, -1
    s_mov_b32 s99, 20000000
Lspin_40:
    ds_read_b32 v5, v251 offset:32
    s_waitcnt lgkmcnt(0)
    v_cmp_gt_u32 vcc, 4, v5
    s_sub_u32 s99, s99, 1
    s_cbranch_scc1 Lspin_40x
    s_cbranch_vccnz Lspin_40
Lspin_40x:
    s_add_u32 m0, s69, 0
    s_nop 0
    buffer_load_dwordx4 v14, s[20:23], s77 offen nt lds
    s_add_u32 m0, s69, 960
    s_nop 0
    buffer_load_dwordx4 v14, s[20:23], s77 offen offset:64 nt lds
    s_add_u32 m0, s69, 1920
    s_nop 0
    buffer_load_dwordx4 v14, s[20:23], s77 offen offset:128 nt lds
    s_mov_b32 s99, 20000000
Lspin_41:
    ds_read_b32 v5, v251 offset:40
    s_waitcnt lgkmcnt(0)
    v_cmp_gt_u32 vcc, 4, v5
    s_sub_u32 s99, s99, 1
    s_cbranch_scc1 Lspin_41x
    s_cbranch_vccnz Lspin_41
Lspin_41x:
    s_add_u32 s77, s77, 44032
    s_add_u32 m0, s69, 3072
    s_nop 0
    buffer_load_dwordx4 v14, s[20:23], s77 offen nt lds
    s_add_u32 m0, s69, 4032
    s_nop 0
    buffer_load_dwordx4 v14, s[20:23], s77 offen offset:64 nt lds
    s_add_u32 m0, s69, 4992
    s_nop 0
    buffer_load_dwordx4 v14, s[20:23], s77 offen offset:128 nt lds
    s_setprio 0
    v_add_u32 v12, 97792, v12
    s_setprio 3
    s_lshl_b32 s50, s46, 4
    s_add_u32 s50, s50, s47
    s_lshl_b32 s50, s50, 13
    s_lshl_b32 s51, s59, 16
    s_add_u32 s50, s50, s51
    s_lshl_b32 s51, s58, 12
    s_add_u32 s50, s50, s51
    s_add_u32 s50, s50, 1572864
    s_xor_b32 s52, s45, 2
    s_mul_i32 s52, s52, 4128
    s_add_u32 s53, s7, 393216
    s_cmp_lt_u32 s46, 4
    s_cbranch_scc1 LBhs
    s_mov_b32 s99, 400000
Lsp_42:
    s_sub_u32 s99, s99, 1
    s_cbranch_scc1 Lsp_42x
    s_buffer_load_dwordx4 s[80:83], s[32:35], s53 glc
    s_waitcnt lgkmcnt(0)
    s_cmp_eq_u64 s[80:81], s[0:1]
    s_cbranch_scc0 Lsp_42
    s_cmp_eq_u64 s[82:83], s[0:1]
    s_cbranch_scc0 Lsp_42
Lsp_42x:
    s_mov_b32 s99, 20000000
Lspin_43:
    ds_read_b32 v5, v251 offset:36
    s_waitcnt lgkmcnt(0)
    v_cmp_gt_u32 vcc, 4, v5
    s_sub_u32 s99, s99, 1
    s_cbranch_scc1 Lspin_43x
    s_cbranch_vccnz Lspin_43
Lspin_43x:
    s_mov_b32 exec_hi, 0
    ds_write_b128 v12, v[16:19] offset:3072
    s_mov_b64 exec, -1
    s_add_u32 m0, s52, 147328
    s_nop 0
    buffer_load_dwordx4 v1, s[32:35], s50 offen sc1 lds
    s_add_u32 m0, s52, 147328
    s_nop 0
    buffer_load_dwordx4 v1, s[32:35], s50 offen offset:1024 sc1 lds
    s_add_u32 m0, s52, 147328
    s_nop 0
    buffer_load_dwordx4 v1, s[32:35], s50 offen offset:2048 sc1 lds
    s_add_u32 m0, s52, 147344
    s_nop 0
    buffer_load_dwordx4 v1, s[32:35], s50 offen offset:3072 sc1 lds
    s_add_u32 s50, s50, 131072
    s_add_u32 m0, s52, 130816
    s_nop 0
    buffer_load_dwordx4 v1, s[32:35], s50 offen sc1 lds
    s_add_u32 m0, s52, 130816
    s_nop 0
    buffer_load_dwordx4 v1, s[32:35], s50 offen offset:1024 sc1 lds
    s_add_u32 m0, s52, 130816
    s_nop 0
    buffer_load_dwordx4 v1, s[32:35], s50 offen offset:2048 sc1 lds
    s_add_u32 m0, s52, 130832
    s_nop 0
    buffer_load_dwordx4 v1, s[32:35], s50 offen offset:3072 sc1 lds
    s_add_u32 s50, s50, 131072
    s_add_u32 m0, s52, 114304
    s_nop 0
    buffer_load_dwordx4 v1, s[32:35], s50 offen sc1 lds
    s_add_u32 m0, s52, 114304
    s_nop 0
    buffer_load_dwordx4 v1, s[32:35], s50 offen offset:1024 sc1 lds
    s_add_u32 m0, s52, 114304
    s_nop 0
    buffer_load_dwordx4 v1, s[32:35], s50 offen offset:2048 sc1 lds
    s_add_u32 m0, s52, 114320
    s_nop 0
    buffer_load_dwordx4 v1, s[32:35], s50 offen offset:3072 sc1 lds
    s_add_u32 s50, s50, 131072
    s_add_u32 m0, s52, 97792
    s_nop 0
    buffer_load_dwordx4 v1, s[32:35], s50 offen sc1 lds
    s_add_u32 m0, s52, 97792
    s_nop 0
    buffer_load_dwordx4 v1, s[32:35], s50 offen offset:1024 sc1 lds
    s_add_u32 m0, s52, 97792
    s_nop 0
    buffer_load_dwordx4 v1, s[32:35], s50 offen offset:2048 sc1 lds
    s_add_u32 m0, s52, 97808
    s_nop 0
    buffer_load_dwordx4 v1, s[32:35], s50 offen offset:3072 sc1 lds
    s_add_u32 s50, s50, 131072
    s_waitcnt vmcnt(8)
    s_mov_b64 exec, 1
    ds_add_u32 v251, v252 offset:112
    s_mov_b64 exec, -1
    s_branch LBhd
LBhs:
    s_mov_b32 s99, 20000000
Lspin_44:
    ds_read_b32 v5, v251 offset:36
    s_waitcnt lgkmcnt(0)
    v_cmp_gt_u32 vcc, 4, v5
    s_sub_u32 s99, s99, 1
    s_cbranch_scc1 Lspin_44x
    s_cbranch_vccnz Lspin_44
Lspin_44x:
    s_mov_b32 exec_hi, 0
    ds_write_b128 v12, v[16:19] offset:3072
    s_mov_b64 exec, -1
    s_add_u32 s50, s50, 131072
    s_add_u32 s53, s53, 4
    s_cmp_lt_u32 s46, 3
    s_cbranch_scc1 Lhg_45
    s_mov_b32 s99, 400000
Lsp_46:
    s_sub_u32 s99, s99, 1
    s_cbranch_scc1 Lsp_46x
    s_buffer_load_dword s80, s[32:35], s53 glc
    s_waitcnt lgkmcnt(0)
    s_cmp_eq_u32 s80, s0
    s_cbranch_scc0 Lsp_46
Lsp_46x:
    s_add_u32 m0, s52, 130816
    s_nop 0
    buffer_load_dwordx4 v1, s[32:35], s50 offen sc1 lds
    s_add_u32 m0, s52, 130816
    s_nop 0
    buffer_load_dwordx4 v1, s[32:35], s50 offen offset:1024 sc1 lds
    s_add_u32 m0, s52, 130816
    s_nop 0
    buffer_load_dwordx4 v1, s[32:35], s50 offen offset:2048 sc1 lds
    s_add_u32 m0, s52, 130832
    s_nop 0
    buffer_load_dwordx4 v1, s[32:35], s50 offen offset:3072 sc1 lds
    s_add_u32 s50, s50, 131072
    s_sub_u32 s50, s50, 131072
Lhg_45:
    s_add_u32 s50, s50, 131072
    s_add_u32 s53, s53, 4
    s_cmp_lt_u32 s46, 2
    s_cbranch_scc1 Lhg_47
    s_mov_b32 s99, 400000
Lsp_48:
    s_sub_u32 s99, s99, 1
    s_cbranch_scc1 Lsp_48x
    s_buffer_load_dword s80, s[32:35], s53 glc
    s_waitcnt lgkmcnt(0)
    s_cmp_eq_u32 s80, s0
    s_cbranch_scc0 Lsp_48
Lsp_48x:
    s_add_u32 m0, s52, 114304
    s_nop 0
    buffer_load_dwordx4 v1, s[32:35], s50 offen sc1 lds
    s_add_u32 m0, s52, 114304
    s_nop 0
    buffer_load_dwordx4 v1, s[32:35], s50 offen offset:1024 sc1 lds
    s_add_u32 m0, s52, 114304
    s_nop 0
    buffer_load_dwordx4 v1, s[32:35], s50 offen offset:2048 sc1 lds
    s_add_u32 m0, s52, 114320
    s_nop 0
    buffer_load_dwordx4 v1, s[32:35], s50 offen offset:3072 sc1 lds
    s_add_u32 s50, s50, 131072
    s_sub_u32 s50, s50, 131072
Lhg_47:
    s_add_u32 s50, s50, 131072
    s_add_u32 s53, s53, 4
    s_cmp_lt_u32 s46, 1
    s_cbranch_scc1 Lhg_49
    s_mov_b32 s99, 400000
Lsp_50:
    s_sub_u32 s99, s99, 1
    s_cbranch_scc1 Lsp_50x
    s_buffer_load_dword s80, s[32:35], s53 glc
    s_waitcnt lgkmcnt(0)
    s_cmp_eq_u32 s80, s0
    s_cbranch_scc0 Lsp_50
Lsp_50x:
    s_add_u32 m0, s52, 97792
    s_nop 0
    buffer_load_dwordx4 v1, s[32:35], s50 offen sc1 lds
    s_add_u32 m0, s52, 97792
    s_nop 0
    buffer_load_dwordx4 v1, s[32:35], s50 offen offset:1024 sc1 lds
    s_add_u32 m0, s52, 97792
    s_nop 0
    buffer_load_dwordx4 v1, s[32:35], s50 offen offset:2048 sc1 lds
    s_add_u32 m0, s52, 97808
    s_nop 0
    buffer_load_dwordx4 v1, s[32:35], s50 offen offset:3072 sc1 lds
    s_add_u32 s50, s50, 131072
    s_sub_u32 s50, s50, 131072
Lhg_49:
    s_add_u32 s50, s50, 131072
    s_waitcnt vmcnt(0)
    s_mov_b64 exec, 1
    ds_add_u32 v251, v252 offset:112
    s_mov_b64 exec, -1
LBhd:
    s_mul_i32 s52, s45, 6144
    s_add_u32 s52, s52, 49152
    v_add_u32 v7, s52, v249
    s_waitcnt vmcnt(16)
    ds_read_b64_tr_b16 v[24:25], v7 offset:0
    ds_read_b64_tr_b16 v[26:27], v7 offset:256
    ds_read_b64_tr_b16 v[28:29], v7 offset:1024
    ds_read_b64_tr_b16 v[30:31], v7 offset:1280
    ds_read_b64_tr_b16 v[32:33], v7 offset:2048
    ds_read_b64_tr_b16 v[34:35], v7 offset:2304
    ds_read_b64_tr_b16 v[36:37], v7 offset:3072
    ds_read_b64_tr_b16 v[38:39], v7 offset:3328
    ds_read_b64_tr_b16 v[40:41], v7 offset:4096
    ds_read_b64_tr_b16 v[42:43], v7 offset:4352
    ds_read_b64_tr_b16 v[44:45], v7 offset:5120
    ds_read_b64_tr_b16 v[46:47], v7 offset:5376
    v_lshrrev_b32 v6, 3, v3
    v_lshl_add_u32 v6, v6, 10, v253
    s_lshl_b32 s50, s59, 18
    s_lshl_b32 s51, s58, 13
    s_add_u32 s50, s50, s51
    s_lshl_b32 s51, s47, 7
    s_add_u32 s50, s50, s51
    s_lshl_b32 s51, s58, 10
    s_mul_i32 s54, s59, 24576
    s_add_u32 s54, s54, s51
    s_add_u32 m0, s54, 0
    s_add_u32 s51, s50, 0
    buffer_load_dwordx4 v6, s[16:19], s51 offen lds
    s_add_u32 m0, s54, 2048
    s_add_u32 s51, s50, 16384
    buffer_load_dwordx4 v6, s[16:19], s51 offen lds
    s_add_u32 m0, s54, 4096
    s_add_u32 s51, s50, 32768
    buffer_load_dwordx4 v6, s[16:19], s51 offen lds
    s_waitcnt vmcnt(3) lgkmcnt(0)
    s_mov_b64 exec, 1
    ds_add_u32 v251, v252 offset:32
    s_mov_b64 exec, -1
    s_setprio 0
    s_add_u32 m0, s54, 6144
    s_add_u32 s51, s50, 49152
    buffer_load_dwordx4 v6, s[16:19], s51 offen lds
    s_add_u32 m0, s54, 8192
    s_add_u32 s51, s50, 65536
    buffer_load_dwordx4 v6, s[16:19], s51 offen lds
    s_add_u32 m0, s54, 10240
    s_add_u32 s51, s50, 81920
    buffer_load_dwordx4 v6, s[16:19], s51 offen lds
    s_add_u32 m0, s54, 12288
    s_add_u32 s51, s50, 98304
    buffer_load_dwordx4 v6, s[16:19], s51 offen lds
    s_add_u32 m0, s54, 14336
    s_add_u32 s51, s50, 114688
    buffer_load_dwordx4 v6, s[16:19], s51 offen lds
    s_add_u32 m0, s54, 16384
    s_add_u32 s51, s50, 131072
    buffer_load_dwordx4 v6, s[16:19], s51 offen lds
    s_add_u32 m0, s54, 18432
    s_add_u32 s51, s50, 147456
    buffer_load_dwordx4 v6, s[16:19], s51 offen lds
    s_add_u32 m0, s54, 20480
    s_add_u32 s51, s50, 163840
    buffer_load_dwordx4 v6, s[16:19], s51 offen lds
    s_add_u32 m0, s54, 22528
    s_add_u32 s51, s50, 180224
    buffer_load_dwordx4 v6, s[16:19], s51 offen lds
    s_add_u32 m0, s52, 0
    s_add_u32 s51, s50, 196608
    buffer_load_dwordx4 v6, s[16:19], s51 offen lds
    s_add_u32 m0, s52, 1024
    s_add_u32 s51, s50, 212992
    buffer_load_dwordx4 v6, s[16:19], s51 offen lds
    s_add_u32 m0, s52, 2048
    s_add_u32 s51, s50, 229376
    buffer_load_dwordx4 v6, s[16:19], s51 offen lds
    s_add_u32 m0, s52, 3072
    s_add_u32 s51, s50, 245760
    buffer_load_dwordx4 v6, s[16:19], s51 offen lds
    s_mov_b32 s72, s50
    v_mov_b32 v11, v6
    s_add_u32 s50, s61, 3072
    buffer_store_dwordx4 v[24:27], v1, s[32:35], s61 offen sc1
    buffer_store_dwordx4 v[28:31], v1, s[32:35], s61 offen offset:1024 sc1
    buffer_store_dwordx4 v[32:35], v1, s[32:35], s61 offen offset:2048 sc1
    buffer_store_dwordx4 v[36:39], v1, s[32:35], s50 offen sc1
    buffer_store_dwordx4 v[40:43], v1, s[32:35], s50 offen offset:1024 sc1
    buffer_store_dwordx4 v[44:47], v1, s[32:35], s50 offen offset:2048 sc1
    s_lshl_b32 s50, s2, 2
    s_add_u32 s50, s50, s45
    s_mul_i32 s50, s50, 5504
    v_lshlrev_b32 v6, 7, v3
    s_mov_b32 exec_hi, 0x7ff
    buffer_load_dword v140, v6, s[24:27], s50 offen
    s_mov_b64 exec, -1
    v_lshlrev_b32 v6, 8, v3
    s_waitcnt vmcnt(7)
    s_mov_b64 exec, 1
    ds_add_u32 v251, v252 offset:108
    s_mov_b64 exec, -1
    s_waitcnt vmcnt(1)
    s_mov_b64 exec, 1
    ds_add_rtn_u32 v5, v251, v252 offset:60
    s_waitcnt lgkmcnt(0)
    v_cmp_eq_u32 vcc, 3, v5
    s_cbranch_vccz Lpush_51
    s_mov_b32 exec_lo, 0xffff
    buffer_store_dword v2, v6, s[32:35], s4 offen sc1
Lpush_51:
    s_mov_b64 exec, -1
    s_cmp_eq_u32 s48, 15
    s_cbranch_scc1 LBw1skip
    s_lshl_b32 s50, s48, 2
    s_add_u32 s50, s50, s45
    s_mul_i32 s56, s50, 98304
    s_add_u32 s56, s56, 12582912
    s_lshl_b32 s53, s45, 4
    s_add_u32 s53, s53, s98
    s_add_u32 s53, s53, 327680
    s_mov_b32 s99, 400000
Lsp_52:
    s_sub_u32 s99, s99, 1
    s_cbranch_scc1 Lsp_52x
    s_buffer_load_dwordx2 s[80:81], s[32:35], s53 glc
    s_waitcnt lgkmcnt(0)
    s_cmp_eq_u64 s[80:81], s[0:1]
    s_cbranch_scc0 Lsp_52
Lsp_52x:
LBw1skip:
    s_cmp_eq_u32 s48, 15
    s_cbranch_scc1 LBw1skip2
    buffer_load_dwordx4 v[72:75], v1, s[32:35], s56 offen sc1
    buffer_load_dwordx4 v[76:79], v1, s[32:35], s56 offen offset:1024 sc1
    buffer_load_dwordx4 v[80:83], v1, s[32:35], s56 offen offset:2048 sc1
    s_add_u32 s56, s56, 3072
    buffer_load_dwordx4 v[84:87], v1, s[32:35], s56 offen sc1
    buffer_load_dwordx4 v[88:91], v1, s[32:35], s56 offen offset:1024 sc1
    buffer_load_dwordx4 v[92:95], v1, s[32:35], s56 offen offset:2048 sc1
    s_add_u32 s56, s56, 3072
    buffer_load_dwordx4 v[96:99], v1, s[32:35], s56 offen sc1
    buffer_load_dwordx4 v[100:103], v1, s[32:35], s56 offen offset:1024 sc1
    buffer_load_dwordx4 v[104:107], v1, s[32:35], s56 offen offset:2048 sc1
    s_add_u32 s56, s56, 3072
    buffer_load_dwordx4 v[108:111], v1, s[32:35], s56 offen sc1
    buffer_load_dwordx4 v[112:115], v1, s[32:35], s56 offen offset:1024 sc1
    buffer_load_dwordx4 v[116:119], v1, s[32:35], s56 offen offset:2048 sc1
    s_add_u32 s56, s56, 3072
    buffer_load_dwordx4 v[120:123], v1, s[32:35], s56 offen sc1
    buffer_load_dwordx4 v[124:127], v1, s[32:35], s56 offen offset:1024 sc1
    buffer_load_dwordx4 v[128:131], v1, s[32:35], s56 offen offset:2048 sc1
    s_add_u32 s56, s56, 3072
    buffer_load_dwordx4 v[132:135], v1, s[32:35], s56 offen sc1
    buffer_load_dwordx4 v[136:139], v1, s[32:35], s56 offen offset:1024 sc1
    buffer_load_dwordx4 v[140:143], v1, s[32:35], s56 offen offset:2048 sc1
    s_add_u32 s56, s56, 3072
    buffer_load_dwordx4 v[144:147], v1, s[32:35], s56 offen sc1
    buffer_load_dwordx4 v[148:151], v1, s[32:35], s56 offen offset:1024 sc1
    buffer_load_dwordx4 v[152:155], v1, s[32:35], s56 offen offset:2048 sc1
    s_add_u32 s56, s56, 3072
    buffer_load_dwordx4 v[156:159], v1, s[32:35], s56 offen sc1
    buffer_load_dwordx4 v[160:163], v1, s[32:35], s56 offen offset:1024 sc1
    buffer_load_dwordx4 v[164:167], v1, s[32:35], s56 offen offset:2048 sc1
    s_add_u32 s56, s56, 3072
    buffer_load_dwordx4 v[168:171], v1, s[32:35], s56 offen sc1
    buffer_load_dwordx4 v[172:175], v1, s[32:35], s56 offen offset:1024 sc1
    buffer_load_dwordx4 v[176:179], v1, s[32:35], s56 offen offset:2048 sc1
    s_add_u32 s56, s56, 3072
    buffer_load_dwordx4 v[180:183], v1, s[32:35], s56 offen sc1
    buffer_load_dwordx4 v[184:187], v1, s[32:35], s56 offen offset:1024 sc1
    buffer_load_dwordx4 v[188:191], v1, s[32:35], s56 offen offset:2048 sc1
    s_add_u32 s56, s56, 3072
    buffer_load_dwordx4 v[192:195], v1, s[32:35], s56 offen sc1
    buffer_load_dwordx4 v[196:199], v1, s[32:35], s56 offen offset:1024 sc1
    buffer_load_dwordx4 v[200:203], v1, s[32:35], s56 offen offset:2048 sc1
    s_add_u32 s56, s56, 3072
    buffer_load_dwordx4 v[204:207], v1, s[32:35], s56 offen sc1
    buffer_load_dwordx4 v[208:211], v1, s[32:35], s56 offen offset:1024 sc1
    buffer_load_dwordx4 v[212:215], v1, s[32:35], s56 offen offset:2048 sc1
    s_add_u32 s56, s56, 3072
    buffer_load_dwordx4 v[216:219], v1, s[32:35], s56 offen sc1
    buffer_load_dwordx4 v[220:223], v1, s[32:35], s56 offen offset:1024 sc1
    buffer_load_dwordx4 v[224:227], v1, s[32:35], s56 offen offset:2048 sc1
    s_add_u32 s56, s56, 3072
    buffer_load_dwordx4 v[228:231], v1, s[32:35], s56 offen sc1
    buffer_load_dwordx4 v[232:235], v1, s[32:35], s56 offen offset:1024 sc1
    buffer_load_dwordx4 v[236:239], v1, s[32:35], s56 offen offset:2048 sc1
    s_add_u32 s56, s56, 3072
LBw1skip2:
    v_mov_b32 v246, 0
    v_mov_b32 v48, 0
    s_mov_b32 s99, 20000000
Lspin_53:
    s_sleep 1
    ds_read_b32 v5, v251 offset:0
    s_waitcnt lgkmcnt(0)
    v_cmp_gt_u32 vcc, 4, v5
    s_sub_u32 s99, s99, 1
    s_cbranch_scc1 Lspin_53x
    s_cbranch_vccnz Lspin_53
Lspin_53x:
    s_mul_i32 s51, s59, 32768
    s_lshl_b32 s50, s58, 10
    s_add_u32 s51, s51, s50
    s_add_u32 s51, s51, 98304
    s_and_b32 s52, s47, 3
    s_mul_i32 s52, s52, 16
    s_lshr_b32 s52, s52, 2
    s_mov_b32 s53, 16
Lw2_54:
    s_lshl_b32 s50, s52, 11
    s_add_u32 m0, s50, s51
    s_lshl_b32 s50, s52, 16
    s_add_u32 s50, s50, s6
    s_add_u32 s50, s50, 0
    buffer_load_dwordx4 v247, s[24:27], s50 offen lds
    s_add_u32 s52, s52, 1
    s_cmp_eq_u32 s52, 16
    s_cselect_b32 s52, 0, s52
    s_sub_u32 s53, s53, 1
    s_cmp_lg_u32 s53, 0
    s_cbranch_scc1 Lw2_54
    s_waitcnt vmcnt(30)
    s_mov_b32 s99, 20000000
Lspin_55:
    s_sleep 1
    ds_read_b32 v5, v251 offset:4
    s_waitcnt lgkmcnt(0)
    v_cmp_gt_u32 vcc, 4, v5
    s_sub_u32 s99, s99, 1
    s_cbranch_scc1 Lspin_55x
    s_cbranch_vccnz Lspin_55
Lspin_55x:
    s_mul_i32 s51, s59, 26624
    s_lshl_b32 s50, s58, 10
    s_add_u32 s51, s51, s50
    s_add_u32 s51, s51, 49152
    s_and_b32 s52, s47, 3
    s_mul_i32 s52, s52, 11
    s_lshr_b32 s52, s52, 2
    s_mov_b32 s53, 11
Lw2_56:
    s_lshl_b32 s50, s52, 11
    s_add_u32 m0, s50, s51
    s_lshl_b32 s50, s52, 16
    s_add_u32 s50, s50, s6
    s_add_u32 s50, s50, 1048576
    buffer_load_dwordx4 v247, s[24:27], s50 offen lds
    s_add_u32 s52, s52, 1
    s_cmp_eq_u32 s52, 11
    s_cselect_b32 s52, 0, s52
    s_sub_u32 s53, s53, 1
    s_cmp_lg_u32 s53, 0
    s_cbranch_scc1 Lw2_56
    s_cmp_eq_u32 s48, 15
    s_cbranch_scc1 LB4skip
    s_mul_i32 s76, s59, 3
    s_lshl_b32 s50, s58, 1
    s_add_u32 s75, s76, s50
    s_add_u32 s76, s76, 1
    v_and_b32 v7, 8, v250
    s_mul_i32 s52, s48, 192
    s_lshl_b32 s53, s75, 5
    s_add_u32 s53, s53, s52
    buffer_load_dwordx2 v[240:241], v7, s[36:39], s53 offen offset:0
    buffer_load_dwordx2 v[242:243], v7, s[36:39], s53 offen offset:16
    v_lshlrev_b32 v7, 1, v7
    s_lshl_b32 s53, s76, 5
    s_add_u32 s53, s53, s52
    s_lshl_b32 s52, s58, 3
    s_add_u32 s53, s53, s52
    buffer_load_dwordx2 v[244:245], v7, s[36:39], s53 offen
    s_lshl_b32 s50, s49, 2
    s_add_u32 s50, s50, s45
    s_lshl_b32 s57, s50, 15
    s_add_u32 s57, s57, 8388608
    s_lshl_b32 s53, s45, 5
    s_add_u32 s53, s53, s98
    s_add_u32 s53, s53, 196608
    s_mov_b32 s99, 20000000
Lspin_57:
    s_sleep 1
    ds_read_b32 v5, v251 offset:48
    s_waitcnt lgkmcnt(0)
    v_cmp_gt_u32 vcc, 4, v5
    s_sub_u32 s99, s99, 1
    s_cbranch_scc1 Lspin_57x
    s_cbranch_vccnz Lspin_57
Lspin_57x:
    s_setprio 3
    s_mov_b32 s99, 400000
Lsp_58:
    s_sub_u32 s99, s99, 1
    s_cbranch_scc1 Lsp_58x
    s_buffer_load_dword s80, s[32:35], s53 glc
    s_waitcnt lgkmcnt(0)
    s_cmp_eq_u32 s80, s0
    s_cbranch_scc0 Lsp_58
Lsp_58x:
    s_mul_i32 s50, s45, 12288
    v_add_u32 v7, s50, v1
    buffer_load_dwordx4 v[8:11], v1, s[32:35], s57 offen sc1
    buffer_load_dwordx4 v[12:15], v1, s[32:35], s57 offen offset:1024 sc1
    s_add_u32 s57, s57, 2048
    buffer_load_dwordx4 v[16:19], v1, s[32:35], s57 offen sc1
    buffer_load_dwordx4 v[20:23], v1, s[32:35], s57 offen offset:1024 sc1
    s_add_u32 s57, s57, 2048
    s_mov_b32 s99, 400000
Lsq_59:
    s_sub_u32 s99, s99, 1
    s_cbranch_scc1 Lsq_59x
    s_buffer_load_dwordx4 s[80:83], s[32:35], s53 glc
    s_waitcnt lgkmcnt(0)
    s_cmp_eq_u32 s81, s0
    s_cbranch_scc0 Lsq_59
Lsq_59x:
    s_waitcnt vmcnt(3)
    v_mfma_f32_32x32x16_bf16 v[24:39], v[72:75], v[8:11], 0
    buffer_load_dwordx4 v[72:75], v1, s[32:35], s57 offen sc1
    v_mfma_f32_32x32x16_bf16 v[40:55], v[76:79], v[8:11], 0
    buffer_load_dwordx4 v[76:79], v1, s[32:35], s57 offen offset:1024 sc1
    s_add_u32 s57, s57, 2048
    v_mfma_f32_32x32x16_bf16 v[56:71], v[80:83], v[8:11], 0
    buffer_load_dwordx4 v[80:83], v1, s[32:35], s57 offen sc1
    s_waitcnt vmcnt(5)
    v_mfma_f32_32x32x16_bf16 v[24:39], v[84:87], v[12:15], v[24:39]
    buffer_load_dwordx4 v[8:11], v1, s[32:35], s57 offen offset:1024 sc1
    s_add_u32 s57, s57, 2048
    v_mfma_f32_32x32x16_bf16 v[40:55], v[88:91], v[12:15], v[40:55]
    s_cmp_eq_u32 s82, s0
    s_cbranch_scc1 Lsq_60x
    s_mov_b32 s99, 400000
Lsq_60:
    s_sub_u32 s99, s99, 1
    s_cbranch_scc1 Lsq_60x
    s_buffer_load_dwordx4 s[80:83], s[32:35], s53 glc
    s_waitcnt lgkmcnt(0)
    s_cmp_eq_u32 s82, s0
    s_cbranch_scc0 Lsq_60
Lsq_60x:
    buffer_load_dwordx4 v[84:87], v1, s[32:35], s57 offen sc1
    v_mfma_f32_32x32x16_bf16 v[56:71], v[92:95], v[12:15], v[56:71]
    buffer_load_dwordx4 v[88:91], v1, s[32:35], s57 offen offset:1024 sc1
    s_add_u32 s57, s57, 2048
    s_waitcnt vmcnt(7)
    v_mfma_f32_32x32x16_bf16 v[24:39], v[96:99], v[16:19], v[24:39]
    buffer_load_dwordx4 v[92:95], v1, s[32:35], s57 offen sc1
    v_mfma_f32_32x32x16_bf16 v[40:55], v[100:103], v[16:19], v[40:55]
    buffer_load_dwordx4 v[12:15], v1, s[32:35], s57 offen offset:1024 sc1
    s_add_u32 s57, s57, 2048
    v_mfma_f32_32x32x16_bf16 v[56:71], v[104:107], v[16:19], v[56:71]
    s_cmp_eq_u32 s83, s0
    s_cbranch_scc1 Lsq_61x
    s_mov_b32 s99, 400000
Lsq_61:
    s_sub_u32 s99, s99, 1
    s_cbranch_scc1 Lsq_61x
    s_buffer_load_dwordx4 s[80:83], s[32:35], s53 glc
    s_waitcnt lgkmcnt(0)
    s_cmp_eq_u32 s83, s0
    s_cbranch_scc0 Lsq_61
Lsq_61x:
    buffer_load_dwordx4 v[96:99], v1, s[32:35], s57 offen sc1
    s_waitcnt vmcnt(9)
    v_mfma_f32_32x32x16_bf16 v[24:39], v[108:111], v[20:23], v[24:39]
    buffer_load_dwordx4 v[100:103], v1, s[32:35], s57 offen offset:1024 sc1
    s_add_u32 s57, s57, 2048
    s_mov_b64 exec, 1
    ds_add_u32 v251, v252 offset:120
    s_mov_b64 exec, -1
    v_mfma_f32_32x32x16_bf16 v[40:55], v[112:115], v[20:23], v[40:55]
    buffer_load_dwordx4 v[104:107], v1, s[32:35], s56 offen sc1
    v_mfma_f32_32x32x16_bf16 v[56:71], v[116:119], v[20:23], v[56:71]
    buffer_load_dwordx4 v[16:19], v1, s[32:35], s56 offen offset:1024 sc1
    s_waitcnt vmcnt(11)
    v_mfma_f32_32x32x16_bf16 v[24:39], v[120:123], v[72:75], v[24:39]
    buffer_load_dwordx4 v[108:111], v1, s[32:35], s56 offen offset:2048 sc1
    s_add_u32 s56, s56, 3072
    v_mfma_f32_32x32x16_bf16 v[40:55], v[124:127], v[72:75], v[40:55]
    buffer_load_dwordx4 v[112:115], v1, s[32:35], s57 offen sc1
    v_mfma_f32_32x32x16_bf16 v[56:71], v[128:131], v[72:75], v[56:71]
    buffer_load_dwordx4 v[116:119], v1, s[32:35], s56 offen sc1
    s_waitcnt vmcnt(13)
    v_mfma_f32_32x32x16_bf16 v[24:39], v[132:135], v[76:79], v[24:39]
    buffer_load_dwordx4 v[20:23], v1, s[32:35], s56 offen offset:1024 sc1
    v_mfma_f32_32x32x16_bf16 v[40:55], v[136:139], v[76:79], v[40:55]
    buffer_load_dwordx4 v[120:123], v1, s[32:35], s56 offen offset:2048 sc1
    s_add_u32 s56, s56, 3072
    v_mfma_f32_32x32x16_bf16 v[56:71], v[140:143], v[76:79], v[56:71]
    buffer_load_dwordx4 v[124:127], v1, s[32:35], s57 offen offset:1024 sc1
    s_add_u32 s57, s57, 2048
    s_waitcnt vmcnt(15)
    v_mfma_f32_32x32x16_bf16 v[24:39], v[144:147], v[80:83], v[24:39]
    v_mfma_f32_32x32x16_bf16 v[40:55], v[148:151], v[80:83], v[40:55]
    v_mfma_f32_32x32x16_bf16 v[56:71], v[152:155], v[80:83], v[56:71]
    s_waitcnt vmcnt(14)
    v_mfma_f32_32x32x16_bf16 v[24:39], v[156:159], v[8:11], v[24:39]
    v_mfma_f32_32x32x16_bf16 v[40:55], v[160:163], v[8:11], v[40:55]
    v_mfma_f32_32x32x16_bf16 v[56:71], v[164:167], v[8:11], v[56:71]
    s_waitcnt vmcnt(13)
    v_mfma_f32_32x32x16_bf16 v[24:39], v[168:171], v[84:87], v[24:39]
    v_mfma_f32_32x32x16_bf16 v[40:55], v[172:175], v[84:87], v[40:55]
    v_mfma_f32_32x32x16_bf16 v[56:71], v[176:179], v[84:87], v[56:71]
    s_waitcnt vmcnt(12)
    v_mfma_f32_32x32x16_bf16 v[24:39], v[180:183], v[88:91], v[24:39]
    v_mfma_f32_32x32x16_bf16 v[40:55], v[184:187], v[88:91], v[40:55]
    v_mfma_f32_32x32x16_bf16 v[56:71], v[188:191], v[88:91], v[56:71]
    s_waitcnt vmcnt(11)
    v_mfma_f32_32x32x16_bf16 v[24:39], v[192:195], v[92:95], v[24:39]
    v_mfma_f32_32x32x16_bf16 v[40:55], v[196:199], v[92:95], v[40:55]
    v_mfma_f32_32x32x16_bf16 v[56:71], v[200:203], v[92:95], v[56:71]
    s_waitcnt vmcnt(10)
    v_mfma_f32_32x32x16_bf16 v[24:39], v[204:207], v[12:15], v[24:39]
    v_mfma_f32_32x32x16_bf16 v[40:55], v[208:211], v[12:15], v[40:55]
    v_mfma_f32_32x32x16_bf16 v[56:71], v[212:215], v[12:15], v[56:71]
    s_waitcnt vmcnt(9)
    v_mfma_f32_32x32x16_bf16 v[24:39], v[216:219], v[96:99], v[24:39]
    v_mfma_f32_32x32x16_bf16 v[40:55], v[220:223], v[96:99], v[40:55]
    v_mfma_f32_32x32x16_bf16 v[56:71], v[224:227], v[96:99], v[56:71]
    s_waitcnt vmcnt(8)
    v_mfma_f32_32x32x16_bf16 v[24:39], v[228:231], v[100:103], v[24:39]
    v_mfma_f32_32x32x16_bf16 v[40:55], v[232:235], v[100:103], v[40:55]
    v_mfma_f32_32x32x16_bf16 v[56:71], v[236:239], v[100:103], v[56:71]
    s_waitcnt vmcnt(4)
    v_mfma_f32_32x32x16_bf16 v[24:39], v[104:107], v[112:115], v[24:39]
    v_mfma_f32_32x32x16_bf16 v[40:55], v[16:19], v[112:115], v[40:55]
    v_mfma_f32_32x32x16_bf16 v[56:71], v[108:111], v[112:115], v[56:71]
    s_waitcnt vmcnt(0)
    v_mfma_f32_32x32x16_bf16 v[24:39], v[116:119], v[124:127], v[24:39]
    v_mfma_f32_32x32x16_bf16 v[40:55], v[20:23], v[124:127], v[40:55]
    v_mfma_f32_32x32x16_bf16 v[56:71], v[120:123], v[124:127], v[56:71]
    s_mov_b32 s99, 20000000
Lspin_62:
    ds_read_b32 v5, v251 offset:52
    s_waitcnt lgkmcnt(0)
    v_cmp_gt_u32 vcc, 4, v5
    s_sub_u32 s99, s99, 1
    s_cbranch_scc1 Lspin_62x
    s_cbranch_vccnz Lspin_62
Lspin_62x:
    s_nop 3
    ds_write_b128 v7, v[24:27] offset:0
    ds_write_b128 v7, v[28:31] offset:1024
    ds_write_b128 v7, v[32:35] offset:2048
    ds_write_b128 v7, v[36:39] offset:3072
    ds_write_b128 v7, v[40:43] offset:4096
    ds_write_b128 v7, v[44:47] offset:5120
    ds_write_b128 v7, v[48:51] offset:6144
    ds_write_b128 v7, v[52:55] offset:7168
    ds_write_b128 v7, v[56:59] offset:8192
    ds_write_b128 v7, v[60:63] offset:9216
    ds_write_b128 v7, v[64:67] offset:10240
    ds_write_b128 v7, v[68:71] offset:11264
    s_mov_b64 exec, 1
    ds_add_u32 v251, v252 offset:8
    s_mov_b64 exec, -1
    s_lshl_b32 s50, s75, 11
    v_add_u32 v72, s50, v1
    v_and_b32 v246, 0x1f0, v1
    v_lshrrev_b32 v6, 5, v3
    v_lshl_add_u32 v73, v6, 10, v246
    s_lshl_b32 s50, s76, 11
    s_lshl_b32 s51, s58, 9
    s_add_u32 s50, s50, s51
    v_add_u32 v73, s50, v73
    v_lshl_add_u32 v246, v6, 3, v246
    v_lshlrev_b32 v8, 16, v240
    v_and_b32 v9, 0xffff0000, v240
    v_lshlrev_b32 v10, 16, v241
    v_and_b32 v11, 0xffff0000, v241
    v_lshlrev_b32 v12, 16, v242
    v_and_b32 v13, 0xffff0000, v242
    v_lshlrev_b32 v14, 16, v243
    v_and_b32 v15, 0xffff0000, v243
    v_lshlrev_b32 v16, 16, v244
    v_and_b32 v17, 0xffff0000, v244
    v_lshlrev_b32 v18, 16, v245
    v_and_b32 v19, 0xffff0000, v245
    s_mov_b32 s99, 20000000
Lspin_63:
    ds_read_b32 v5, v251 offset:8
    s_waitcnt lgkmcnt(0)
    v_cmp_gt_u32 vcc, 4, v5
    s_sub_u32 s99, s99, 1
    s_cbranch_scc1 Lspin_63x
    s_cbranch_vccnz Lspin_63
Lspin_63x:
    ds_read_b128 v[80:83], v72 offset:0
    ds_read_b128 v[84:87], v72 offset:1024
    ds_read_b128 v[88:91], v73 offset:0
    ds_read_b128 v[92:95], v72 offset:12288
    ds_read_b128 v[96:99], v72 offset:13312
    ds_read_b128 v[100:103], v73 offset:12288
    ds_read_b128 v[104:107], v72 offset:24576
    ds_read_b128 v[108:111], v72 offset:25600
    ds_read_b128 v[112:115], v73 offset:24576
    ds_read_b128 v[116:119], v72 offset:36864
    ds_read_b128 v[120:123], v72 offset:37888
    ds_read_b128 v[124:127], v73 offset:36864
    s_waitcnt lgkmcnt(9)
    v_add_f32 v8, v8, v80
    v_add_f32 v9, v9, v81
    v_add_f32 v10, v10, v82
    v_add_f32 v11, v11, v83
    v_add_f32 v12, v12, v84
    v_add_f32 v13, v13, v85
    v_add_f32 v14, v14, v86
    v_add_f32 v15, v15, v87
    v_add_f32 v16, v16, v88
    v_add_f32 v17, v17, v89
    v_add_f32 v18, v18, v90
    v_add_f32 v19, v19, v91
    s_waitcnt lgkmcnt(6)
    v_add_f32 v8, v8, v92
    v_add_f32 v9, v9, v93
    v_add_f32 v10, v10, v94
    v_add_f32 v11, v11, v95
    v_add_f32 v12, v12, v96
    v_add_f32 v13, v13, v97
    v_add_f32 v14, v14, v98
    v_add_f32 v15, v15, v99
    v_add_f32 v16, v16, v100
    v_add_f32 v17, v17, v101
    v_add_f32 v18, v18, v102
    v_add_f32 v19, v19, v103
    s_waitcnt lgkmcnt(3)
    v_add_f32 v8, v8, v104
    v_add_f32 v9, v9, v105
    v_add_f32 v10, v10, v106
    v_add_f32 v11, v11, v107
    v_add_f32 v12, v12, v108
    v_add_f32 v13, v13, v109
    v_add_f32 v14, v14, v110
    v_add_f32 v15, v15, v111
    v_add_f32 v16, v16, v112
    v_add_f32 v17, v17, v113
    v_add_f32 v18, v18, v114
    v_add_f32 v19, v19, v115
    s_waitcnt lgkmcnt(0)
    v_add_f32 v8, v8, v116
    v_add_f32 v9, v9, v117
    v_add_f32 v10, v10, v118
    v_add_f32 v11, v11, v119
    v_add_f32 v12, v12, v120
    v_add_f32 v13, v13, v121
    v_add_f32 v14, v14, v122
    v_add_f32 v15, v15, v123
    v_add_f32 v16, v16, v124
    v_add_f32 v17, v17, v125
    v_add_f32 v18, v18, v126
    v_add_f32 v19, v19, v127
    s_mov_b64 exec, 1
    ds_add_u32 v251, v252 offset:12
    s_mov_b64 exec, -1
    v_mov_b32 v20, 0xbdd2d3e8
    v_mov_b32 v22, 0xc0135761
    s_mul_i32 s50, s49, 98304
    s_mul_i32 s51, s48, 6144
    s_add_u32 s50, s50, s51
    s_add_u32 s50, s50, 10485760
    s_lshl_b32 s64, s75, 10
    s_add_u32 s64, s64, s50
    s_lshl_b32 s65, s76, 10
    s_add_u32 s65, s65, s50
    s_lshl_b32 s51, s58, 9
    s_add_u32 s65, s65, s51
    v_lshlrev_b32 v48, 11, v3
    s_lshr_b32 s50, s49, 1
    s_lshl_b32 s50, s50, 8
    s_and_b32 s51, s49, 1
    s_lshl_b32 s51, s51, 6
    s_add_u32 s50, s50, s51
    s_lshl_b32 s51, s48, 2
    s_add_u32 s50, s50, s51
    s_add_u32 s67, s50, 262144
LB4skip:
    s_waitcnt vmcnt(0) lgkmcnt(0)
    s_barrier
    s_cmp_eq_u32 s48, 15
    s_cbranch_scc1 LB4skip2
    ds_read_b128 v[80:83], v72 offset:0
    ds_read_b128 v[84:87], v72 offset:1024
    ds_read_b128 v[88:91], v73 offset:0
    ds_read_b128 v[92:95], v72 offset:12288
    ds_read_b128 v[96:99], v72 offset:13312
    ds_read_b128 v[100:103], v73 offset:12288
    ds_read_b128 v[104:107], v72 offset:24576
    ds_read_b128 v[108:111], v72 offset:25600
    ds_read_b128 v[112:115], v73 offset:24576
    ds_read_b128 v[116:119], v72 offset:36864
    ds_read_b128 v[120:123], v72 offset:37888
    ds_read_b128 v[124:127], v73 offset:36864
    s_waitcnt lgkmcnt(9)
    v_pk_add_f32 v[8:9], v[8:9], v[80:81]
    v_pk_add_f32 v[10:11], v[10:11], v[82:83]
    v_pk_add_f32 v[12:13], v[12:13], v[84:85]
    v_pk_add_f32 v[14:15], v[14:15], v[86:87]
    v_pk_add_f32 v[16:17], v[16:17], v[88:89]
    v_pk_add_f32 v[18:19], v[18:19], v[90:91]
    s_waitcnt lgkmcnt(6)
    v_pk_add_f32 v[8:9], v[8:9], v[92:93]
    v_pk_add_f32 v[10:11], v[10:11], v[94:95]
    v_pk_add_f32 v[12:13], v[12:13], v[96:97]
    v_pk_add_f32 v[14:15], v[14:15], v[98:99]
    v_pk_add_f32 v[16:17], v[16:17], v[100:101]
    v_pk_add_f32 v[18:19], v[18:19], v[102:103]
    s_waitcnt lgkmcnt(3)
    v_pk_add_f32 v[8:9], v[8:9], v[104:105]
    v_pk_add_f32 v[10:11], v[10:11], v[106:107]
    v_pk_add_f32 v[12:13], v[12:13], v[108:109]
    v_pk_add_f32 v[14:15], v[14:15], v[110:111]
    v_pk_add_f32 v[16:17], v[16:17], v[112:113]
    v_pk_add_f32 v[18:19], v[18:19], v[114:115]
    s_waitcnt lgkmcnt(0)
    v_pk_add_f32 v[8:9], v[8:9], v[116:117]
    v_pk_add_f32 v[10:11], v[10:11], v[118:119]
    v_pk_add_f32 v[12:13], v[12:13], v[120:121]
    v_pk_add_f32 v[14:15], v[14:15], v[122:123]
    v_pk_add_f32 v[16:17], v[16:17], v[124:125]
    v_pk_add_f32 v[18:19], v[18:19], v[126:127]
    s_mov_b64 exec, 1
    ds_add_u32 v251, v252 offset:24
    s_mov_b64 exec, -1
    v_pk_mul_f32 v[24:25], v[8:9], v[8:9]
    v_pk_mul_f32 v[26:27], v[10:11], v[10:11]
    v_pk_mul_f32 v[28:29], v[12:13], v[12:13]
    v_pk_mul_f32 v[30:31], v[14:15], v[14:15]
    v_pk_mul_f32 v[32:33], v[16:17], v[16:17]
    v_pk_mul_f32 v[34:35], v[18:19], v[18:19]
    v_pk_fma_f32 v[24:25], v[24:25], v[20:21], v[22:23] op_sel_hi:[1,0,0]
    v_pk_fma_f32 v[26:27], v[26:27], v[20:21], v[22:23] op_sel_hi:[1,0,0]
    v_pk_fma_f32 v[28:29], v[28:29], v[20:21], v[22:23] op_sel_hi:[1,0,0]
    v_pk_fma_f32 v[30:31], v[30:31], v[20:21], v[22:23] op_sel_hi:[1,0,0]
    v_pk_fma_f32 v[32:33], v[32:33], v[20:21], v[22:23] op_sel_hi:[1,0,0]
    v_pk_fma_f32 v[34:35], v[34:35], v[20:21], v[22:23] op_sel_hi:[1,0,0]
    v_pk_mul_f32 v[24:25], v[24:25], v[8:9]
    v_pk_mul_f32 v[26:27], v[26:27], v[10:11]
    v_pk_mul_f32 v[28:29], v[28:29], v[12:13]
    v_pk_mul_f32 v[30:31], v[30:31], v[14:15]
    v_pk_mul_f32 v[32:33], v[32:33], v[16:17]
    v_pk_mul_f32 v[34:35], v[34:35], v[18:19]
    v_exp_f32 v24, v24
    v_exp_f32 v25, v25
    v_exp_f32 v26, v26
    v_exp_f32 v27, v27
    v_exp_f32 v28, v28
    v_exp_f32 v29, v29
    v_exp_f32 v30, v30
    v_exp_f32 v31, v31
    v_exp_f32 v32, v32
    v_exp_f32 v33, v33
    v_exp_f32 v34, v34
    v_exp_f32 v35, v35
    v_pk_add_f32 v[24:25], v[24:25], 1.0 op_sel_hi:[1,0]
    v_pk_add_f32 v[26:27], v[26:27], 1.0 op_sel_hi:[1,0]
    v_pk_add_f32 v[28:29], v[28:29], 1.0 op_sel_hi:[1,0]
    v_pk_add_f32 v[30:31], v[30:31], 1.0 op_sel_hi:[1,0]
    v_pk_add_f32 v[32:33], v[32:33], 1.0 op_sel_hi:[1,0]
    v_pk_add_f32 v[34:35], v[34:35], 1.0 op_sel_hi:[1,0]
    v_rcp_f32 v24, v24
    v_rcp_f32 v25, v25
    v_rcp_f32 v26, v26
    v_rcp_f32 v27, v27
    v_rcp_f32 v28, v28
    v_rcp_f32 v29, v29
    v_rcp_f32 v30, v30
    v_rcp_f32 v31, v31
    v_rcp_f32 v32, v32
    v_rcp_f32 v33, v33
    v_rcp_f32 v34, v34
    v_rcp_f32 v35, v35
    v_pk_mul_f32 v[8:9], v[8:9], v[24:25]
    v_pk_mul_f32 v[10:11], v[10:11], v[26:27]
    v_pk_mul_f32 v[12:13], v[12:13], v[28:29]
    v_pk_mul_f32 v[14:15], v[14:15], v[30:31]
    v_cvt_pk_bf16_f32 v40, v8, v9
    v_cvt_pk_bf16_f32 v41, v10, v11
    v_cvt_pk_bf16_f32 v42, v12, v13
    v_cvt_pk_bf16_f32 v43, v14, v15
    buffer_store_dwordx4 v[40:43], v1, s[32:35], s64 offen sc1
    v_pk_mul_f32 v[16:17], v[16:17], v[32:33]
    v_pk_mul_f32 v[18:19], v[18:19], v[34:35]
    v_cvt_pk_bf16_f32 v44, v16, v17
    v_cvt_pk_bf16_f32 v45, v18, v19
    v_mov_b64 v[46:47], v[44:45]
    s_nop 1
    v_permlane32_swap_b32 v44, v46
    v_permlane32_swap_b32 v45, v47
    s_mov_b32 exec_hi, 0
    buffer_store_dwordx4 v[44:47], v1, s[32:35], s65 offen sc1
    s_waitcnt vmcnt(0)
    s_mov_b64 exec, 1
    ds_add_rtn_u32 v5, v251, v252 offset:56
    s_waitcnt lgkmcnt(0)
    v_cmp_eq_u32 vcc, 3, v5
    s_cbranch_vccz Lpush_64
    s_mov_b32 exec_lo, 0xffffffff
    buffer_store_dword v2, v48, s[32:35], s67 offen sc1
Lpush_64:
    s_mov_b64 exec, -1
    s_branch LB5
LB4skip2:
    s_mov_b64 exec, 1
    ds_add_u32 v251, v252 offset:24
    s_mov_b64 exec, -1
LB5:
    s_setprio 0
    s_mov_b32 s99, 20000000
Lspin_65:
    ds_read_b32 v5, v251 offset:16
    s_waitcnt lgkmcnt(0)
    v_cmp_gt_u32 vcc, 4, v5
    s_sub_u32 s99, s99, 1
    s_cbranch_scc1 Lspin_65x
    s_cbranch_vccnz Lspin_65
Lspin_65x:
    s_mul_i32 s51, s59, 32768
    s_lshl_b32 s50, s58, 10
    s_add_u32 s51, s51, s50
    s_add_u32 s51, s51, 114688
    s_and_b32 s52, s47, 3
    s_mul_i32 s52, s52, 8
    s_lshr_b32 s52, s52, 2
    s_mov_b32 s53, 8
Lw2_66:
    s_lshl_b32 s50, s52, 11
    s_add_u32 m0, s50, s51
    s_lshl_b32 s50, s52, 16
    s_add_u32 s50, s50, s6
    s_add_u32 s50, s50, 2293760
    buffer_load_dwordx4 v247, s[24:27], s50 offen lds
    s_add_u32 s52, s52, 1
    s_cmp_eq_u32 s52, 8
    s_cselect_b32 s52, 0, s52
    s_sub_u32 s53, s53, 1
    s_cmp_lg_u32 s53, 0
    s_cbranch_scc1 Lw2_66
    s_waitcnt vmcnt(0)
    s_mov_b64 exec, 1
    ds_add_u32 v251, v252 offset:20
    s_mov_b64 exec, -1
Lend:
    s_endpgm
.p2align 6
LA:
    s_setprio 2
    s_load_dwordx2 s[32:33], s[0:1], 80
    s_load_dwordx2 s[16:17], s[0:1], 16
    s_load_dwordx2 s[20:21], s[0:1], 32
    s_load_dwordx2 s[36:37], s[0:1], 40
    s_load_dwordx2 s[24:25], s[0:1], 48
    s_load_dwordx2 s[40:41], s[0:1], 56
    s_load_dwordx2 s[28:29], s[0:1], 64
    s_mov_b32 s18, 524288
    s_mov_b32 s19, 0x20000
    s_mov_b32 s22, 5636096
    s_mov_b32 s23, 0x20000
    s_mov_b32 s38, 2752
    s_mov_b32 s39, 0x20000
    s_mov_b32 s26, 5636096
    s_mov_b32 s27, 0x20000
    s_mov_b32 s42, 4096
    s_mov_b32 s43, 0x20000
    s_mov_b32 s30, 2097152
    s_mov_b32 s31, 0x20000
    s_mov_b32 s34, 18874368
    s_mov_b32 s35, 0x20000
    v_lshlrev_b32 v4, 2, v3
    s_bfe_u32 s50, s2, 0x20001
    s_bfe_u32 s51, s2, 0x20003
    s_lshl_b32 s48, s50, 2
    s_add_u32 s48, s48, s51
    s_lshr_b32 s51, s2, 5
    s_and_b32 s49, s2, 1
    s_lshl_b32 s49, s49, 3
    s_add_u32 s49, s49, s51
    s_and_b32 s58, s45, 1
    s_lshr_b32 s59, s45, 1
    s_waitcnt lgkmcnt(0)
    s_load_dword s44, s[32:33], 0
    v_bfe_u32 v5, v3, 2, 2
    v_bfe_u32 v6, v3, 4, 1
    v_lshlrev_b32 v6, 5, v6
    v_and_b32 v7, 3, v3
    v_lshl_add_u32 v6, v7, 3, v6
    v_lshl_add_u32 v248, v5, 7, v6
    v_lshl_add_u32 v249, v5, 6, v6
    v_lshrrev_b32 v5, 1, v5
    v_lshl_add_u32 v248, v5, 6, v248
    v_lshrrev_b32 v5, 5, v3
    v_lshl_add_u32 v249, v5, 9, v249
    v_and_b32 v6, 31, v3
    v_lshlrev_b32 v5, 3, v5
    v_lshl_add_u32 v250, v6, 6, v5
    v_mov_b32 v251, 73728
    v_mov_b32 v252, 1
    s_lshl_b32 s62, s46, 1
    s_add_u32 s62, s62, s58
    s_lshl_b32 s63, s62, 3
    s_add_u32 s63, s63, s47
    s_lshl_b32 s63, s63, 1
    s_add_u32 s63, s63, s59
    s_lshl_b32 s7, s46, 3
    s_add_u32 s7, s7, s47
    s_lshl_b32 s7, s7, 8
    s_lshl_b32 s98, s48, 4
    s_add_u32 s98, s98, s49
    s_lshl_b32 s98, s98, 8
    s_cmp_lg_u32 s45, 0
    s_cbranch_scc1 LAnw
    v_lshlrev_b32 v5, 16, v3
    s_mov_b64 exec, 0x56
    buffer_load_dword v16, v5, s[32:35], s7 offen sc1
    s_mov_b64 exec, 0x28
    buffer_load_dword v17, v5, s[32:35], s98 offen sc1
    s_mov_b64 exec, 0x1fe
    v_lshlrev_b32 v5, 21, v3
    buffer_load_dword v18, v5, s[32:35], 0 offen
    s_mov_b64 exec, 7
    buffer_load_dword v19, v5, s[20:23], 0 offen
    buffer_load_dword v20, v5, s[24:27], 0 offen
    s_mov_b64 exec, 1
    buffer_load_dword v21, v5, s[28:31], 0 offen
    buffer_load_dword v22, v5, s[16:19], 0 offen
    s_mov_b32 exec_hi, 0
    s_mov_b32 exec_lo, -1
    v_add_u32 v5, v4, v251
    v_mov_b32 v6, 0
    ds_write_b32 v5, v6
    s_mov_b64 exec, -1
LAnw:
    v_lshrrev_b32 v6, 5, v250
    s_lshl_b32 s50, s62, 6
    buffer_load_ushort v254, v6, s[40:43], s50 offen
    s_lshl_b32 s50, s62, 15
    s_lshl_b32 s51, s47, 7
    s_add_u32 s50, s50, s51
    s_lshl_b32 s51, s59, 6
    s_add_u32 s61, s50, s51
    s_sub_u32 s56, s47, s60
    s_and_b32 s56, s56, 7
    s_mul_i32 s52, s56, 43
    s_lshr_b32 s52, s52, 7
    s_mul_i32 s52, s52, 3
    s_sub_u32 s52, s56, s52
    s_mul_i32 s52, s52, 24576
    v_and_b32 v5, 31, v3
    v_lshrrev_b32 v6, 5, v3
    v_bfe_u32 v7, v3, 1, 3
    s_lshl_b32 s50, s58, 12
    s_add_u32 s52, s52, s50
    s_lshl_b32 s51, s59, 2
    v_xor_b32 v247, s51, v7
    v_lshlrev_b32 v247, 4, v247
    v_lshl_add_u32 v247, v6, 3, v247
    v_lshl_add_u32 v247, v5, 7, v247
    v_add_u32 v247, s52, v247
    v_xor_b32 v7, v7, v6
    v_lshlrev_b32 v7, 4, v7
    v_lshl_add_u32 v80, v5, 7, v7
    v_add_u32 v80, s50, v80
    v_xor_b32 v81, 32, v80
    v_xor_b32 v82, 64, v80
    v_xor_b32 v83, 96, v80
    v_lshl_add_u32 v84, v6, 10, v248
    s_lshl_b32 s51, s59, 6
    v_xor_b32 v84, s51, v84
    v_add_u32 v84, 8192, v84
    v_lshrrev_b32 v7, 2, v3
    v_xor_b32 v7, v7, v3
    v_and_b32 v7, 4, v7
    v_cmp_eq_u32 vcc, 0, v7
    v_mov_b32 v7, 0x3f803f80
    s_nop 0
    v_cndmask_b32 v236, 0, v7, vcc
    v_cndmask_b32 v237, 0, v7, vcc
    v_cndmask_b32 v238, 0, v7, vcc
    v_cndmask_b32 v239, 0, v7, vcc
    v_mov_b32 v85, 0
    v_mov_b32 v66, 0
    v_mov_b32 v67, 0
    v_mov_b32 v74, 0
    v_mov_b32 v75, 0
    s_lshl_b32 s54, s62, 12
    s_add_u32 s54, s54, 524288
    s_lshl_b32 s55, s47, 2
    s_lshr_b32 s50, s46, 3
    s_add_u32 s55, s55, s50
    s_lshl_b32 s55, s55, 1
    s_add_u32 s55, s55, s59
    s_lshl_b32 s55, s55, 12
    s_add_u32 s55, s55, 786432
    s_waitcnt lgkmcnt(0)
    s_mul_i32 s0, s44, 1664525
    s_add_u32 s0, s0, 1013904223
    s_mov_b32 s1, s0
    v_mov_b32 v2, s0
    s_barrier
    ds_read_b128 v[112:115], v80 offset:0
    ds_read_b64_tr_b16 v[88:89], v84 offset:0
    ds_read_b64_tr_b16 v[90:91], v84 offset:512
    ds_read_b64_tr_b16 v[92:93], v84 offset:8192
    ds_read_b64_tr_b16 v[94:95], v84 offset:8704
    ds_read_b128 v[116:119], v81 offset:0
    ds_read_b64_tr_b16 v[96:97], v84 offset:2048
    ds_read_b64_tr_b16 v[98:99], v84 offset:2560
    ds_read_b64_tr_b16 v[100:101], v84 offset:10240
    ds_read_b64_tr_b16 v[102:103], v84 offset:10752
    s_waitcnt lgkmcnt(5)
    v_mfma_f32_32x32x16_bf16 v[32:47], v[88:91], v[112:115], 0
    ds_read_b128 v[120:123], v82 offset:0
    ds_read_b64_tr_b16 v[104:105], v84 offset:4096
    ds_read_b64_tr_b16 v[106:107], v84 offset:4608
    v_mfma_f32_32x32x16_bf16 v[48:63], v[112:115], v[92:95], 0
    ds_read_b64_tr_b16 v[108:109], v84 offset:12288
    ds_read_b64_tr_b16 v[110:111], v84 offset:12800
    s_cmp_lg_u32 s4, 0
    s_cbranch_scc1 Lst_1
    v_mfma_f32_16x16x32_bf16 v[224:227], v[236:239], v[88:91], 0
    v_mfma_f32_16x16x32_bf16 v[232:235], v[236:239], v[112:115], 0
    v_mfma_f32_16x16x32_bf16 v[228:231], v[236:239], v[92:95], 0
    v_dot2_f32_bf16 v85, v112, v112, v85
    v_dot2_f32_bf16 v85, v113, v113, v85
    v_dot2_f32_bf16 v85, v114, v114, v85
    v_dot2_f32_bf16 v85, v115, v115, v85
Lst_1:
    s_waitcnt lgkmcnt(5)
    v_mfma_f32_32x32x16_bf16 v[32:47], v[96:99], v[116:119], v[32:47]
    ds_read_b128 v[124:127], v83 offset:0
    ds_read_b64_tr_b16 v[88:89], v84 offset:6144
    ds_read_b64_tr_b16 v[90:91], v84 offset:6656
    v_mfma_f32_32x32x16_bf16 v[48:63], v[116:119], v[100:103], v[48:63]
    ds_read_b64_tr_b16 v[92:93], v84 offset:14336
    ds_read_b64_tr_b16 v[94:95], v84 offset:14848
    s_cmp_lg_u32 s4, 0
    s_cbranch_scc1 Lst_2
    v_mfma_f32_16x16x32_bf16 v[224:227], v[236:239], v[96:99], v[224:227]
    v_mfma_f32_16x16x32_bf16 v[232:235], v[236:239], v[116:119], v[232:235]
    v_mfma_f32_16x16x32_bf16 v[228:231], v[236:239], v[100:103], v[228:231]
    v_dot2_f32_bf16 v85, v116, v116, v85
    v_dot2_f32_bf16 v85, v117, v117, v85
    v_dot2_f32_bf16 v85, v118, v118, v85
    v_dot2_f32_bf16 v85, v119, v119, v85
Lst_2:
    s_cmp_lg_u32 s56, 0
    s_cbranch_scc1 Lnx_3
    v_xor_b32 v5, 16, v247
    v_xor_b32 v6, 32, v247
    v_xor_b32 v7, 48, v247
    ds_read_b64 v[240:241], v247
    ds_read_b64 v[242:243], v5
    ds_read_b64 v[244:245], v6
    ds_read_b64 v[246:247], v7
Lnx_3:
    s_waitcnt lgkmcnt(0)
    s_cmp_lg_u32 s4, 0
    s_cbranch_scc1 Lst_4
    v_mfma_f32_16x16x32_bf16 v[224:227], v[236:239], v[104:107], v[224:227]
    v_mfma_f32_16x16x32_bf16 v[232:235], v[236:239], v[120:123], v[232:235]
    v_mfma_f32_16x16x32_bf16 v[228:231], v[236:239], v[108:111], v[228:231]
    v_dot2_f32_bf16 v85, v120, v120, v85
    v_dot2_f32_bf16 v85, v121, v121, v85
    v_dot2_f32_bf16 v85, v122, v122, v85
    v_dot2_f32_bf16 v85, v123, v123, v85
    v_mfma_f32_16x16x32_bf16 v[224:227], v[236:239], v[88:91], v[224:227]
    v_mfma_f32_16x16x32_bf16 v[232:235], v[236:239], v[124:127], v[232:235]
    v_mfma_f32_16x16x32_bf16 v[228:231], v[236:239], v[92:95], v[228:231]
    v_dot2_f32_bf16 v85, v124, v124, v85
    v_dot2_f32_bf16 v85, v125, v125, v85
    v_dot2_f32_bf16 v85, v126, v126, v85
    v_dot2_f32_bf16 v85, v127, v127, v85
    s_lshl_b32 s51, s47, 9
    s_add_u32 s51, s51, s54
    s_and_b32 s52, s46, 7
    s_lshl_b32 s52, s52, 9
    s_add_u32 s52, s52, s55
    v_mov_b32 v5, v85
    s_nop 1
    v_permlane32_swap_b32 v85, v5
    v_add_f32 v85, v85, v5
    v_mov_b32 v233, v85
    v_mov_b32 v235, v2
    v_mov_b32 v225, v228
    v_mov_b32 v227, v2
    s_mov_b32 exec_hi, 0
    s_cmp_lg_u32 s59, 0
    s_cbranch_scc1 LAs1_0
    buffer_store_dwordx4 v[232:235], v1, s[32:35], s51 offen sc1
LAs1_0:
    s_cmp_lg_u32 s58, 0
    s_cbranch_scc1 LAs2_0
    buffer_store_dwordx4 v[224:227], v1, s[32:35], s52 offen sc1
LAs2_0:
    s_mov_b64 exec, -1
Lst_4:
    s_barrier
    v_mfma_f32_32x32x16_bf16 v[32:47], v[104:107], v[120:123], v[32:47]
    ds_read_b128 v[128:131], v80 offset:24576
    ds_read_b64_tr_b16 v[96:97], v84 offset:24576
    ds_read_b64_tr_b16 v[98:99], v84 offset:25088
    v_mfma_f32_32x32x16_bf16 v[48:63], v[120:123], v[108:111], v[48:63]
    ds_read_b64_tr_b16 v[100:101], v84 offset:32768
    ds_read_b64_tr_b16 v[102:103], v84 offset:33280
    v_mfma_f32_32x32x16_bf16 v[32:47], v[88:91], v[124:127], v[32:47]
    ds_read_b128 v[132:135], v81 offset:24576
    ds_read_b64_tr_b16 v[104:105], v84 offset:26624
    ds_read_b64_tr_b16 v[106:107], v84 offset:27136
    v_mfma_f32_32x32x16_bf16 v[48:63], v[124:127], v[92:95], v[48:63]
    ds_read_b64_tr_b16 v[108:109], v84 offset:34816
    ds_read_b64_tr_b16 v[110:111], v84 offset:35328
    s_waitcnt lgkmcnt(5)
    v_mfma_f32_32x32x16_bf16 v[32:47], v[96:99], v[128:131], v[32:47]
    ds_read_b128 v[136:139], v82 offset:24576
    ds_read_b64_tr_b16 v[88:89], v84 offset:28672
    ds_read_b64_tr_b16 v[90:91], v84 offset:29184
    v_mfma_f32_32x32x16_bf16 v[48:63], v[128:131], v[100:103], v[48:63]
    ds_read_b64_tr_b16 v[92:93], v84 offset:36864
    ds_read_b64_tr_b16 v[94:95], v84 offset:37376
    s_cmp_lg_u32 s4, 1
    s_cbranch_scc1 Lst_5
    v_mfma_f32_16x16x32_bf16 v[224:227], v[236:239], v[96:99], 0
    v_mfma_f32_16x16x32_bf16 v[232:235], v[236:239], v[128:131], 0
    v_mfma_f32_16x16x32_bf16 v[228:231], v[236:239], v[100:103], 0
    v_dot2_f32_bf16 v85, v128, v128, v85
    v_dot2_f32_bf16 v85, v129, v129, v85
    v_dot2_f32_bf16 v85, v130, v130, v85
    v_dot2_f32_bf16 v85, v131, v131, v85
Lst_5:
    s_waitcnt lgkmcnt(5)
    v_mfma_f32_32x32x16_bf16 v[32:47], v[104:107], v[132:135], v[32:47]
    ds_read_b128 v[140:143], v83 offset:24576
    ds_read_b64_tr_b16 v[96:97], v84 offset:30720
    ds_read_b64_tr_b16 v[98:99], v84 offset:31232
    v_mfma_f32_32x32x16_bf16 v[48:63], v[132:135], v[108:111], v[48:63]
    ds_read_b64_tr_b16 v[100:101], v84 offset:38912
    ds_read_b64_tr_b16 v[102:103], v84 offset:39424
    s_cmp_lg_u32 s4, 1
    s_cbranch_scc1 Lst_6
    v_mfma_f32_16x16x32_bf16 v[224:227], v[236:239], v[104:107], v[224:227]
    v_mfma_f32_16x16x32_bf16 v[232:235], v[236:239], v[132:135], v[232:235]
    v_mfma_f32_16x16x32_bf16 v[228:231], v[236:239], v[108:111], v[228:231]
    v_dot2_f32_bf16 v85, v132, v132, v85
    v_dot2_f32_bf16 v85, v133, v133, v85
    v_dot2_f32_bf16 v85, v134, v134, v85
    v_dot2_f32_bf16 v85, v135, v135, v85
Lst_6:
    s_cmp_lg_u32 s56, 1
    s_cbranch_scc1 Lnx_7
    v_xor_b32 v5, 16, v247
    v_xor_b32 v6, 32, v247
    v_xor_b32 v7, 48, v247
    ds_read_b64 v[240:241], v247
    ds_read_b64 v[242:243], v5
    ds_read_b64 v[244:245], v6
    ds_read_b64 v[246:247], v7
Lnx_7:
    s_waitcnt lgkmcnt(0)
    s_cmp_lg_u32 s4, 1
    s_cbranch_scc1 Lst_8
    v_mfma_f32_16x16x32_bf16 v[224:227], v[236:239], v[88:91], v[224:227]
    v_mfma_f32_16x16x32_bf16 v[232:235], v[236:239], v[136:139], v[232:235]
    v_mfma_f32_16x16x32_bf16 v[228:231], v[236:239], v[92:95], v[228:231]
    v_dot2_f32_bf16 v85, v136, v136, v85
    v_dot2_f32_bf16 v85, v137, v137, v85
    v_dot2_f32_bf16 v85, v138, v138, v85
    v_dot2_f32_bf16 v85, v139, v139, v85
    v_mfma_f32_16x16x32_bf16 v[224:227], v[236:239], v[96:99], v[224:227]
    v_mfma_f32_16x16x32_bf16 v[232:235], v[236:239], v[140:143], v[232:235]
    v_mfma_f32_16x16x32_bf16 v[228:231], v[236:239], v[100:103], v[228:231]
    v_dot2_f32_bf16 v85, v140, v140, v85
    v_dot2_f32_bf16 v85, v141, v141, v85
    v_dot2_f32_bf16 v85, v142, v142, v85
    v_dot2_f32_bf16 v85, v143, v143, v85
    s_lshl_b32 s51, s47, 9
    s_add_u32 s51, s51, s54
    s_and_b32 s52, s46, 7
    s_lshl_b32 s52, s52, 9
    s_add_u32 s52, s52, s55
    v_mov_b32 v5, v85
    s_nop 1
    v_permlane32_swap_b32 v85, v5
    v_add_f32 v85, v85, v5
    v_mov_b32 v233, v85
    v_mov_b32 v235, v2
    v_mov_b32 v225, v228
    v_mov_b32 v227, v2
    s_mov_b32 exec_hi, 0
    s_cmp_lg_u32 s59, 0
    s_cbranch_scc1 LAs1_1
    buffer_store_dwordx4 v[232:235], v1, s[32:35], s51 offen sc1
LAs1_1:
    s_cmp_lg_u32 s58, 0
    s_cbranch_scc1 LAs2_1
    buffer_store_dwordx4 v[224:227], v1, s[32:35], s52 offen sc1
LAs2_1:
    s_mov_b64 exec, -1
Lst_8:
    s_barrier
    v_mfma_f32_32x32x16_bf16 v[32:47], v[88:91], v[136:139], v[32:47]
    ds_read_b128 v[144:147], v80 offset:49152
    ds_read_b64_tr_b16 v[104:105], v84 offset:49152
    ds_read_b64_tr_b16 v[106:107], v84 offset:49664
    v_mfma_f32_32x32x16_bf16 v[48:63], v[136:139], v[92:95], v[48:63]
    ds_read_b64_tr_b16 v[108:109], v84 offset:57344
    ds_read_b64_tr_b16 v[110:111], v84 offset:57856
    v_mfma_f32_32x32x16_bf16 v[32:47], v[96:99], v[140:143], v[32:47]
    ds_read_b128 v[148:151], v81 offset:49152
    ds_read_b64_tr_b16 v[88:89], v84 offset:51200
    ds_read_b64_tr_b16 v[90:91], v84 offset:51712
    v_mfma_f32_32x32x16_bf16 v[48:63], v[140:143], v[100:103], v[48:63]
    ds_read_b64_tr_b16 v[92:93], v84 offset:59392
    ds_read_b64_tr_b16 v[94:95], v84 offset:59904
    s_waitcnt lgkmcnt(5)
    v_mfma_f32_32x32x16_bf16 v[32:47], v[104:107], v[144:147], v[32:47]
    ds_read_b128 v[152:155], v82 offset:49152
    ds_read_b64_tr_b16 v[96:97], v84 offset:53248
    ds_read_b64_tr_b16 v[98:99], v84 offset:53760
    v_mfma_f32_32x32x16_bf16 v[48:63], v[144:147], v[108:111], v[48:63]
    ds_read_b64_tr_b16 v[100:101], v84 offset:61440
    ds_read_b64_tr_b16 v[102:103], v84 offset:61952
    s_waitcnt lgkmcnt(5)
    v_mfma_f32_32x32x16_bf16 v[32:47], v[88:91], v[148:151], v[32:47]
    ds_read_b128 v[156:159], v83 offset:49152
    ds_read_b64_tr_b16 v[104:105], v84 offset:55296
    ds_read_b64_tr_b16 v[106:107], v84 offset:55808
    v_mfma_f32_32x32x16_bf16 v[48:63], v[148:151], v[92:95], v[48:63]
    ds_read_b64_tr_b16 v[108:109], v84 offset:63488
    ds_read_b64_tr_b16 v[110:111], v84 offset:64000
    s_cmp_lg_u32 s56, 2
    s_cbranch_scc1 Lnx_9
    v_xor_b32 v5, 16, v247
    v_xor_b32 v6, 32, v247
    v_xor_b32 v7, 48, v247
    ds_read_b64 v[240:241], v247
    ds_read_b64 v[242:243], v5
    ds_read_b64 v[244:245], v6
    ds_read_b64 v[246:247], v7
Lnx_9:
    s_waitcnt lgkmcnt(0)
    s_barrier
    v_mfma_f32_32x32x16_bf16 v[32:47], v[96:99], v[152:155], v[32:47]
    ds_read_b128 v[160:163], v80 offset:0
    ds_read_b64_tr_b16 v[88:89], v84 offset:0
    ds_read_b64_tr_b16 v[90:91], v84 offset:512
    v_mfma_f32_32x32x16_bf16 v[48:63], v[152:155], v[100:103], v[48:63]
    ds_read_b64_tr_b16 v[92:93], v84 offset:8192
    ds_read_b64_tr_b16 v[94:95], v84 offset:8704
    v_mfma_f32_32x32x16_bf16 v[32:47], v[104:107], v[156:159], v[32:47]
    ds_read_b128 v[164:167], v81 offset:0
    ds_read_b64_tr_b16 v[96:97], v84 offset:2048
    ds_read_b64_tr_b16 v[98:99], v84 offset:2560
    v_mfma_f32_32x32x16_bf16 v[48:63], v[156:159], v[108:111], v[48:63]
    ds_read_b64_tr_b16 v[100:101], v84 offset:10240
    ds_read_b64_tr_b16 v[102:103], v84 offset:10752
    s_waitcnt lgkmcnt(5)
    v_mfma_f32_32x32x16_bf16 v[32:47], v[88:91], v[160:163], v[32:47]
    ds_read_b128 v[168:171], v82 offset:0
    ds_read_b64_tr_b16 v[104:105], v84 offset:4096
    ds_read_b64_tr_b16 v[106:107], v84 offset:4608
    v_mfma_f32_32x32x16_bf16 v[48:63], v[160:163], v[92:95], v[48:63]
    ds_read_b64_tr_b16 v[108:109], v84 offset:12288
    ds_read_b64_tr_b16 v[110:111], v84 offset:12800
    s_waitcnt lgkmcnt(5)
    v_mfma_f32_32x32x16_bf16 v[32:47], v[96:99], v[164:167], v[32:47]
    ds_read_b128 v[172:175], v83 offset:0
    ds_read_b64_tr_b16 v[88:89], v84 offset:6144
    ds_read_b64_tr_b16 v[90:91], v84 offset:6656
    v_mfma_f32_32x32x16_bf16 v[48:63], v[164:167], v[100:103], v[48:63]
    ds_read_b64_tr_b16 v[92:93], v84 offset:14336
    ds_read_b64_tr_b16 v[94:95], v84 offset:14848
    s_cmp_lg_u32 s56, 3
    s_cbranch_scc1 Lnx_10
    v_xor_b32 v5, 16, v247
    v_xor_b32 v6, 32, v247
    v_xor_b32 v7, 48, v247
    ds_read_b64 v[240:241], v247
    ds_read_b64 v[242:243], v5
    ds_read_b64 v[244:245], v6
    ds_read_b64 v[246:247], v7
Lnx_10:
    s_waitcnt lgkmcnt(0)
    s_barrier
    v_mfma_f32_32x32x16_bf16 v[32:47], v[104:107], v[168:171], v[32:47]
    ds_read_b128 v[176:179], v80 offset:24576
    ds_read_b64_tr_b16 v[96:97], v84 offset:24576
    ds_read_b64_tr_b16 v[98:99], v84 offset:25088
    v_mfma_f32_32x32x16_bf16 v[48:63], v[168:171], v[108:111], v[48:63]
    ds_read_b64_tr_b16 v[100:101], v84 offset:32768
    ds_read_b64_tr_b16 v[102:103], v84 offset:33280
    v_mfma_f32_32x32x16_bf16 v[32:47], v[88:91], v[172:175], v[32:47]
    ds_read_b128 v[180:183], v81 offset:24576
    ds_read_b64_tr_b16 v[104:105], v84 offset:26624
    ds_read_b64_tr_b16 v[106:107], v84 offset:27136
    v_mfma_f32_32x32x16_bf16 v[48:63], v[172:175], v[92:95], v[48:63]
    ds_read_b64_tr_b16 v[108:109], v84 offset:34816
    ds_read_b64_tr_b16 v[110:111], v84 offset:35328
    s_waitcnt lgkmcnt(5)
    v_mfma_f32_32x32x16_bf16 v[32:47], v[96:99], v[176:179], v[32:47]
    ds_read_b128 v[184:187], v82 offset:24576
    ds_read_b64_tr_b16 v[88:89], v84 offset:28672
    ds_read_b64_tr_b16 v[90:91], v84 offset:29184
    v_mfma_f32_32x32x16_bf16 v[48:63], v[176:179], v[100:103], v[48:63]
    ds_read_b64_tr_b16 v[92:93], v84 offset:36864
    ds_read_b64_tr_b16 v[94:95], v84 offset:37376
    s_waitcnt lgkmcnt(5)
    v_mfma_f32_32x32x16_bf16 v[32:47], v[104:107], v[180:183], v[32:47]
    ds_read_b128 v[188:191], v83 offset:24576
    ds_read_b64_tr_b16 v[96:97], v84 offset:30720
    ds_read_b64_tr_b16 v[98:99], v84 offset:31232
    v_mfma_f32_32x32x16_bf16 v[48:63], v[180:183], v[108:111], v[48:63]
    ds_read_b64_tr_b16 v[100:101], v84 offset:38912
    ds_read_b64_tr_b16 v[102:103], v84 offset:39424
    s_cmp_lg_u32 s56, 4
    s_cbranch_scc1 Lnx_11
    v_xor_b32 v5, 16, v247
    v_xor_b32 v6, 32, v247
    v_xor_b32 v7, 48, v247
    ds_read_b64 v[240:241], v247
    ds_read_b64 v[242:243], v5
    ds_read_b64 v[244:245], v6
    ds_read_b64 v[246:247], v7
Lnx_11:
    s_waitcnt lgkmcnt(0)
    s_barrier
    v_mfma_f32_32x32x16_bf16 v[32:47], v[88:91], v[184:187], v[32:47]
    ds_read_b128 v[192:195], v80 offset:49152
    ds_read_b64_tr_b16 v[104:105], v84 offset:49152
    ds_read_b64_tr_b16 v[106:107], v84 offset:49664
    v_mfma_f32_32x32x16_bf16 v[48:63], v[184:187], v[92:95], v[48:63]
    ds_read_b64_tr_b16 v[108:109], v84 offset:57344
    ds_read_b64_tr_b16 v[110:111], v84 offset:57856
    v_mfma_f32_32x32x16_bf16 v[32:47], v[96:99], v[188:191], v[32:47]
    ds_read_b128 v[196:199], v81 offset:49152
    ds_read_b64_tr_b16 v[88:89], v84 offset:51200
    ds_read_b64_tr_b16 v[90:91], v84 offset:51712
    v_mfma_f32_32x32x16_bf16 v[48:63], v[188:191], v[100:103], v[48:63]
    ds_read_b64_tr_b16 v[92:93], v84 offset:59392
    ds_read_b64_tr_b16 v[94:95], v84 offset:59904
    s_waitcnt lgkmcnt(5)
    v_mfma_f32_32x32x16_bf16 v[32:47], v[104:107], v[192:195], v[32:47]
    ds_read_b128 v[200:203], v82 offset:49152
    ds_read_b64_tr_b16 v[96:97], v84 offset:53248
    ds_read_b64_tr_b16 v[98:99], v84 offset:53760
    v_mfma_f32_32x32x16_bf16 v[48:63], v[192:195], v[108:111], v[48:63]
    ds_read_b64_tr_b16 v[100:101], v84 offset:61440
    ds_read_b64_tr_b16 v[102:103], v84 offset:61952
    s_waitcnt lgkmcnt(5)
    v_mfma_f32_32x32x16_bf16 v[32:47], v[88:91], v[196:199], v[32:47]
    ds_read_b128 v[204:207], v83 offset:49152
    ds_read_b64_tr_b16 v[104:105], v84 offset:55296
    ds_read_b64_tr_b16 v[106:107], v84 offset:55808
    v_mfma_f32_32x32x16_bf16 v[48:63], v[196:199], v[92:95], v[48:63]
    ds_read_b64_tr_b16 v[108:109], v84 offset:63488
    ds_read_b64_tr_b16 v[110:111], v84 offset:64000
    s_cmp_lg_u32 s56, 5
    s_cbranch_scc1 Lnx_12
    v_xor_b32 v5, 16, v247
    v_xor_b32 v6, 32, v247
    v_xor_b32 v7, 48, v247
    ds_read_b64 v[240:241], v247
    ds_read_b64 v[242:243], v5
    ds_read_b64 v[244:245], v6
    ds_read_b64 v[246:247], v7
Lnx_12:
    buffer_load_dwordx4 v[16:19], v1, s[32:35], s54 offen sc1
    buffer_load_dwordx4 v[20:23], v1, s[32:35], s54 offen offset:1024 sc1
    buffer_load_dwordx4 v[24:27], v1, s[32:35], s54 offen offset:2048 sc1
    buffer_load_dwordx4 v[28:31], v1, s[32:35], s54 offen offset:3072 sc1
    buffer_load_dwordx4 v[8:11], v1, s[32:35], s55 offen sc1
    buffer_load_dwordx4 v[12:15], v1, s[32:35], s55 offen offset:1024 sc1
    buffer_load_dwordx4 v[68:71], v1, s[32:35], s55 offen offset:2048 sc1
    buffer_load_dwordx4 v[76:79], v1, s[32:35], s55 offen offset:3072 sc1
    s_waitcnt lgkmcnt(0)
    s_barrier
    v_mfma_f32_32x32x16_bf16 v[32:47], v[96:99], v[200:203], v[32:47]
    ds_read_b128 v[208:211], v80 offset:0
    ds_read_b64_tr_b16 v[88:89], v84 offset:0
    ds_read_b64_tr_b16 v[90:91], v84 offset:512
    v_mfma_f32_32x32x16_bf16 v[48:63], v[200:203], v[100:103], v[48:63]
    ds_read_b64_tr_b16 v[92:93], v84 offset:8192
    ds_read_b64_tr_b16 v[94:95], v84 offset:8704
    v_mfma_f32_32x32x16_bf16 v[32:47], v[104:107], v[204:207], v[32:47]
    ds_read_b128 v[212:215], v81 offset:0
    ds_read_b64_tr_b16 v[96:97], v84 offset:2048
    ds_read_b64_tr_b16 v[98:99], v84 offset:2560
    v_mfma_f32_32x32x16_bf16 v[48:63], v[204:207], v[108:111], v[48:63]
    ds_read_b64_tr_b16 v[100:101], v84 offset:10240
    ds_read_b64_tr_b16 v[102:103], v84 offset:10752
    s_waitcnt lgkmcnt(5)
    v_mfma_f32_32x32x16_bf16 v[32:47], v[88:91], v[208:211], v[32:47]
    ds_read_b128 v[216:219], v82 offset:0
    ds_read_b64_tr_b16 v[104:105], v84 offset:4096
    ds_read_b64_tr_b16 v[106:107], v84 offset:4608
    v_mfma_f32_32x32x16_bf16 v[48:63], v[208:211], v[92:95], v[48:63]
    ds_read_b64_tr_b16 v[108:109], v84 offset:12288
    ds_read_b64_tr_b16 v[110:111], v84 offset:12800
    s_waitcnt lgkmcnt(5)
    v_mfma_f32_32x32x16_bf16 v[32:47], v[96:99], v[212:215], v[32:47]
    ds_read_b128 v[220:223], v83 offset:0
    ds_read_b64_tr_b16 v[88:89], v84 offset:6144
    ds_read_b64_tr_b16 v[90:91], v84 offset:6656
    v_mfma_f32_32x32x16_bf16 v[48:63], v[212:215], v[100:103], v[48:63]
    ds_read_b64_tr_b16 v[92:93], v84 offset:14336
    ds_read_b64_tr_b16 v[94:95], v84 offset:14848
    s_cmp_lg_u32 s56, 6
    s_cbranch_scc1 Lnx_13
    v_xor_b32 v5, 16, v247
    v_xor_b32 v6, 32, v247
    v_xor_b32 v7, 48, v247
    ds_read_b64 v[240:241], v247
    ds_read_b64 v[242:243], v5
    ds_read_b64 v[244:245], v6
    ds_read_b64 v[246:247], v7
Lnx_13:
    s_waitcnt lgkmcnt(0)
    s_barrier
    v_mfma_f32_32x32x16_bf16 v[32:47], v[104:107], v[216:219], v[32:47]
    ds_read_b128 v[224:227], v80 offset:24576
    ds_read_b64_tr_b16 v[96:97], v84 offset:24576
    ds_read_b64_tr_b16 v[98:99], v84 offset:25088
    v_mfma_f32_32x32x16_bf16 v[48:63], v[216:219], v[108:111], v[48:63]
    ds_read_b64_tr_b16 v[100:101], v84 offset:32768
    ds_read_b64_tr_b16 v[102:103], v84 offset:33280
    v_mfma_f32_32x32x16_bf16 v[32:47], v[88:91], v[220:223], v[32:47]
    ds_read_b128 v[228:231], v81 offset:24576
    ds_read_b64_tr_b16 v[104:105], v84 offset:26624
    ds_read_b64_tr_b16 v[106:107], v84 offset:27136
    v_mfma_f32_32x32x16_bf16 v[48:63], v[220:223], v[92:95], v[48:63]
    ds_read_b64_tr_b16 v[108:109], v84 offset:34816
    ds_read_b64_tr_b16 v[110:111], v84 offset:35328
    s_mov_b32 s99, 400000
    s_branch LAchk
LAre:
    buffer_load_dwordx4 v[16:19], v1, s[32:35], s54 offen sc1
    buffer_load_dwordx4 v[20:23], v1, s[32:35], s54 offen offset:1024 sc1
    buffer_load_dwordx4 v[24:27], v1, s[32:35], s54 offen offset:2048 sc1
    buffer_load_dwordx4 v[28:31], v1, s[32:35], s54 offen offset:3072 sc1
    buffer_load_dwordx4 v[8:11], v1, s[32:35], s55 offen sc1
    buffer_load_dwordx4 v[12:15], v1, s[32:35], s55 offen offset:1024 sc1
    buffer_load_dwordx4 v[68:71], v1, s[32:35], s55 offen offset:2048 sc1
    buffer_load_dwordx4 v[76:79], v1, s[32:35], s55 offen offset:3072 sc1
LAchk:
    s_waitcnt vmcnt(0)
    v_xor_b32 v5, v2, v19
    v_xor_b32 v6, v2, v23
    v_or_b32 v5, v5, v6
    v_xor_b32 v6, v2, v27
    v_or_b32 v5, v5, v6
    v_xor_b32 v6, v2, v31
    v_or_b32 v5, v5, v6
    v_xor_b32 v6, v2, v11
    v_or_b32 v5, v5, v6
    v_xor_b32 v6, v2, v15
    v_or_b32 v5, v5, v6
    v_xor_b32 v6, v2, v71
    v_or_b32 v5, v5, v6
    v_xor_b32 v6, v2, v79
    v_or_b32 v5, v5, v6
    v_cmp_ne_u32 vcc, 0, v5
    s_sub_u32 s99, s99, 1
    s_cbranch_scc1 LAok
    s_cbranch_vccnz LAre
LAok:
    v_add_f32 v16, v16, v20
    v_add_f32 v24, v24, v28
    v_add_f32 v16, v16, v24
    v_add_f32 v8, v8, v12
    v_add_f32 v68, v68, v76
    v_add_f32 v8, v8, v68
    v_add_f32 v17, v17, v21
    v_add_f32 v25, v25, v29
    v_add_f32 v17, v17, v25
    v_add_f32 v9, v9, v13
    v_add_f32 v69, v69, v77
    v_add_f32 v9, v9, v69
    v_mov_b64 v[20:21], v[16:17]
    v_mov_b64 v[12:13], v[8:9]
    v_cmp_gt_u32 vcc, 32, v3
    s_mov_b32 s50, 0xffff
    v_permlane32_swap_b32 v16, v20
    v_permlane32_swap_b32 v8, v12
    v_permlane32_swap_b32 v17, v21
    v_permlane32_swap_b32 v9, v13
    v_add_f32 v16, v16, v20
    v_add_f32 v8, v8, v12
    v_add_f32 v17, v17, v21
    v_add_f32 v9, v9, v13
    v_mul_f32 v87, 0xbb000000, v16
    v_mul_f32 v17, 0x3b000000, v17
    v_fma_f32 v17, -v87, v87, v17
    v_max_f32 v17, 0, v17
    v_add_f32 v17, 0x3727c5ac, v17
    v_rsq_f32 v86, v17
    v_cvt_pk_bf16_f32 v5, v87, v87
    v_and_b32 v6, 0xffff0000, v5
    v_sub_f32 v6, v87, v6
    v_cvt_pk_bf16_f32 v6, v6, v6
    v_cndmask_b32 v64, 0, v5, vcc
    v_and_b32 v6, 0xffff, v6
    v_cndmask_b32 v65, 0, v6, vcc
    v_cvt_pk_bf16_f32 v73, v8, v8
    v_and_b32 v6, 0xffff0000, v73
    v_sub_f32 v6, v8, v6
    v_cvt_pk_bf16_f32 v6, v6, v6
    v_bfi_b32 v72, s50, v73, v6
    v_mov_b64 v[78:79], 0
    v_mov_b64 v[70:71], 0
    v_mov_b32 v69, 0
    v_cvt_pk_bf16_f32 v5, v86, v86
    v_and_b32 v7, 0xffff0000, v5
    v_sub_f32 v7, v86, v7
    v_cvt_pk_bf16_f32 v7, v7, v7
    v_mfma_f32_32x32x16_bf16 v[32:47], v[72:75], v[64:67], v[32:47]
    v_cvt_pk_bf16_f32 v77, v9, v9
    v_and_b32 v6, 0xffff0000, v77
    v_sub_f32 v6, v9, v6
    v_cvt_pk_bf16_f32 v6, v6, v6
    v_bfi_b32 v76, s50, v77, v6
    v_bfi_b32 v5, s50, v5, v7
    v_cndmask_b32 v68, 0, v5, vcc
    v_mfma_f32_32x32x16_bf16 v[48:63], v[64:67], v[76:79], v[48:63]
    v_mov_b32 v12, 0x3f803f80
    v_mov_b32 v13, 0x3f803f80
    v_mov_b32 v14, 0x3f803f80
    v_mov_b32 v15, 0x3f803f80
    s_nop 1
    v_mfma_f32_32x32x16_bf16 v[16:31], v[68:71], v[12:15], 0
    s_waitcnt lgkmcnt(5)
    v_mfma_f32_32x32x16_bf16 v[32:47], v[96:99], v[224:227], v[32:47]
    ds_read_b128 v[232:235], v82 offset:24576
    ds_read_b64_tr_b16 v[88:89], v84 offset:28672
    ds_read_b64_tr_b16 v[90:91], v84 offset:29184
    v_mfma_f32_32x32x16_bf16 v[48:63], v[224:227], v[100:103], v[48:63]
    ds_read_b64_tr_b16 v[92:93], v84 offset:36864
    ds_read_b64_tr_b16 v[94:95], v84 offset:37376
    s_waitcnt lgkmcnt(5)
    v_mfma_f32_32x32x16_bf16 v[32:47], v[104:107], v[228:231], v[32:47]
    ds_read_b128 v[236:239], v83 offset:24576
    ds_read_b64_tr_b16 v[96:97], v84 offset:30720
    ds_read_b64_tr_b16 v[98:99], v84 offset:31232
    v_mfma_f32_32x32x16_bf16 v[48:63], v[228:231], v[108:111], v[48:63]
    ds_read_b64_tr_b16 v[100:101], v84 offset:38912
    ds_read_b64_tr_b16 v[102:103], v84 offset:39424
    s_cmp_lg_u32 s56, 7
    s_cbranch_scc1 Lnx_14
    v_xor_b32 v5, 16, v247
    v_xor_b32 v6, 32, v247
    v_xor_b32 v7, 48, v247
    ds_read_b64 v[240:241], v247
    ds_read_b64 v[242:243], v5
    ds_read_b64 v[244:245], v6
    ds_read_b64 v[246:247], v7
Lnx_14:
    s_waitcnt lgkmcnt(0)
    v_mfma_f32_32x32x16_bf16 v[32:47], v[88:91], v[232:235], v[32:47]
    v_mfma_f32_32x32x16_bf16 v[48:63], v[232:235], v[92:95], v[48:63]
    v_mfma_f32_32x32x16_bf16 v[32:47], v[96:99], v[236:239], v[32:47]
    v_mfma_f32_32x32x16_bf16 v[48:63], v[236:239], v[100:103], v[48:63]
    s_lshl_b32 s52, s63, 12
    s_add_u32 s52, s52, 2097152
    s_xor_b32 s51, s58, 1
    s_lshl_b32 s51, s51, 1
    s_add_u32 s51, s51, s59
    s_mul_i32 s51, s51, 4128
    s_add_u32 s51, s51, 81280
    v_add_u32 v80, s51, v1
    v_mul_u32_u24 v81, 2044, v3
    v_sub_u32 v81, 8192, v81
    v_add_u32 v84, 90112, v84
    v_mul_f32 v32, v86, v32
    v_mul_f32 v33, v86, v33
    v_mul_f32 v34, v86, v34
    v_mul_f32 v35, v86, v35
    v_mul_f32 v36, v86, v36
    v_mul_f32 v37, v86, v37
    v_mul_f32 v38, v86, v38
    v_mul_f32 v39, v86, v39
    v_cvt_pk_bf16_f32 v88, v32, v33
    v_cvt_pk_bf16_f32 v89, v34, v35
    v_cvt_pk_bf16_f32 v90, v36, v37
    v_cvt_pk_bf16_f32 v91, v38, v39
    buffer_store_dwordx4 v[88:91], v1, s[32:35], s52 offen sc1
    v_pk_mul_f32 v[40:41], v[40:41], v[86:87] op_sel_hi:[1,0]
    v_pk_mul_f32 v[42:43], v[42:43], v[86:87] op_sel_hi:[1,0]
    v_pk_mul_f32 v[44:45], v[44:45], v[86:87] op_sel_hi:[1,0]
    v_pk_mul_f32 v[46:47], v[46:47], v[86:87] op_sel_hi:[1,0]
    v_cvt_pk_bf16_f32 v92, v40, v41
    v_cvt_pk_bf16_f32 v93, v42, v43
    v_cvt_pk_bf16_f32 v94, v44, v45
    v_cvt_pk_bf16_f32 v95, v46, v47
    buffer_store_dwordx4 v[92:95], v1, s[32:35], s52 offen offset:1024 sc1
    v_pk_mul_f32 v[48:49], v[48:49], v[16:17]
    v_pk_mul_f32 v[50:51], v[50:51], v[18:19]
    v_pk_mul_f32 v[52:53], v[52:53], v[20:21]
    v_pk_mul_f32 v[54:55], v[54:55], v[22:23]
    v_cvt_pk_bf16_f32 v96, v48, v49
    v_cvt_pk_bf16_f32 v97, v50, v51
    v_cvt_pk_bf16_f32 v98, v52, v53
    v_cvt_pk_bf16_f32 v99, v54, v55
    buffer_store_dwordx4 v[96:99], v1, s[32:35], s52 offen offset:2048 sc1
    v_pk_mul_f32 v[56:57], v[56:57], v[24:25]
    v_pk_mul_f32 v[58:59], v[58:59], v[26:27]
    v_pk_mul_f32 v[60:61], v[60:61], v[28:29]
    v_pk_mul_f32 v[62:63], v[62:63], v[30:31]
    v_cvt_pk_bf16_f32 v100, v56, v57
    v_cvt_pk_bf16_f32 v101, v58, v59
    v_cvt_pk_bf16_f32 v102, v60, v61
    v_cvt_pk_bf16_f32 v103, v62, v63
    buffer_store_dwordx4 v[100:103], v1, s[32:35], s52 offen offset:3072 sc1
    ds_write_b128 v80, v[88:91] offset:0
    ds_write_b128 v80, v[92:95] offset:1024
    ds_write_b128 v80, v[96:99] offset:2048
    ds_write_b128 v80, v[100:103] offset:3088
    s_mov_b64 exec, 1
    ds_write_b128 v80, v[12:15] offset:3072
    ds_write_b128 v80, v[12:15] offset:4112
    s_mov_b64 exec, 1
    ds_add_u32 v251, v252 offset:32
    s_mov_b64 exec, -1
    v_lshrrev_b32 v7, 2, v3
    v_xor_b32 v7, v7, v3
    v_and_b32 v7, 4, v7
    v_cmp_eq_u32 vcc, 0, v7
    v_mov_b32 v7, 0x3f803f80
    s_nop 0
    v_cndmask_b32 v68, 0, v7, vcc
    v_cndmask_b32 v69, 0, v7, vcc
    v_cndmask_b32 v70, 0, v7, vcc
    v_cndmask_b32 v71, 0, v7, vcc
    s_add_u32 s54, s7, 393216
    s_mov_b32 s99, 20000000
Lspin_15:
    ds_read_b32 v5, v251 offset:96
    s_waitcnt lgkmcnt(0)
    v_cmp_gt_u32 vcc, 4, v5
    s_sub_u32 s99, s99, 1
    s_cbranch_scc1 Lspin_15x
    s_cbranch_vccnz Lspin_15
Lspin_15x:
    ds_read_b64_tr_b16 v[32:33], v84 offset:0
    ds_read_b64_tr_b16 v[34:35], v84 offset:512
    ds_read_b64_tr_b16 v[36:37], v84 offset:2048
    ds_read_b64_tr_b16 v[38:39], v84 offset:2560
    ds_read_b64_tr_b16 v[40:41], v84 offset:4096
    ds_read_b64_tr_b16 v[42:43], v84 offset:4608
    ds_read_b64_tr_b16 v[44:45], v84 offset:6144
    ds_read_b64_tr_b16 v[46:47], v84 offset:6656
    ds_read_b64_tr_b16 v[48:49], v84 offset:8192
    ds_read_b64_tr_b16 v[50:51], v84 offset:8704
    ds_read_b64_tr_b16 v[52:53], v84 offset:10240
    ds_read_b64_tr_b16 v[54:55], v84 offset:10752
    ds_read_b64_tr_b16 v[56:57], v84 offset:12288
    ds_read_b64_tr_b16 v[58:59], v84 offset:12800
    s_waitcnt lgkmcnt(12)
    v_mfma_f32_32x32x16_bf16 v[16:31], v[32:35], v[112:115], 0
    ds_read_b64_tr_b16 v[60:61], v84 offset:14336
    ds_read_b64_tr_b16 v[62:63], v84 offset:14848
    v_mfma_f32_16x16x32_bf16 v[76:79], v[68:71], v[32:35], 0
    s_waitcnt lgkmcnt(12)
    v_mfma_f32_32x32x16_bf16 v[16:31], v[36:39], v[116:119], v[16:31]
    ds_read_b64_tr_b16 v[32:33], v84 offset:16384
    ds_read_b64_tr_b16 v[34:35], v84 offset:16896
    v_mfma_f32_16x16x32_bf16 v[76:79], v[68:71], v[36:39], v[76:79]
    s_waitcnt lgkmcnt(12)
    v_mfma_f32_32x32x16_bf16 v[16:31], v[40:43], v[120:123], v[16:31]
    ds_read_b64_tr_b16 v[36:37], v84 offset:18432
    ds_read_b64_tr_b16 v[38:39], v84 offset:18944
    v_mfma_f32_16x16x32_bf16 v[76:79], v[68:71], v[40:43], v[76:79]
    s_waitcnt lgkmcnt(12)
    v_mfma_f32_32x32x16_bf16 v[16:31], v[44:47], v[124:127], v[16:31]
    ds_read_b64_tr_b16 v[40:41], v84 offset:20480
    ds_read_b64_tr_b16 v[42:43], v84 offset:20992
    v_mfma_f32_16x16x32_bf16 v[76:79], v[68:71], v[44:47], v[76:79]
    s_waitcnt lgkmcnt(12)
    v_mfma_f32_32x32x16_bf16 v[16:31], v[48:51], v[128:131], v[16:31]
    ds_read_b64_tr_b16 v[44:45], v84 offset:22528
    ds_read_b64_tr_b16 v[46:47], v84 offset:23040
    v_mfma_f32_16x16x32_bf16 v[76:79], v[68:71], v[48:51], v[76:79]
    s_waitcnt lgkmcnt(12)
    v_mfma_f32_32x32x16_bf16 v[16:31], v[52:55], v[132:135], v[16:31]
    ds_read_b64_tr_b16 v[48:49], v84 offset:24576
    ds_read_b64_tr_b16 v[50:51], v84 offset:25088
    v_mfma_f32_16x16x32_bf16 v[76:79], v[68:71], v[52:55], v[76:79]
    s_waitcnt lgkmcnt(12)
    v_mfma_f32_32x32x16_bf16 v[16:31], v[56:59], v[136:139], v[16:31]
    ds_read_b64_tr_b16 v[52:53], v84 offset:26624
    ds_read_b64_tr_b16 v[54:55], v84 offset:27136
    v_mfma_f32_16x16x32_bf16 v[76:79], v[68:71], v[56:59], v[76:79]
    s_waitcnt lgkmcnt(12)
    v_mfma_f32_32x32x16_bf16 v[16:31], v[60:63], v[140:143], v[16:31]
    ds_read_b64_tr_b16 v[56:57], v84 offset:28672
    ds_read_b64_tr_b16 v[58:59], v84 offset:29184
    v_mfma_f32_16x16x32_bf16 v[76:79], v[68:71], v[60:63], v[76:79]
    s_waitcnt lgkmcnt(12)
    v_mfma_f32_32x32x16_bf16 v[16:31], v[32:35], v[144:147], v[16:31]
    ds_read_b64_tr_b16 v[60:61], v84 offset:30720
    ds_read_b64_tr_b16 v[62:63], v84 offset:31232
    v_mfma_f32_16x16x32_bf16 v[76:79], v[68:71], v[32:35], v[76:79]
    s_waitcnt lgkmcnt(12)
    v_mfma_f32_32x32x16_bf16 v[16:31], v[36:39], v[148:151], v[16:31]
    ds_read_b64_tr_b16 v[32:33], v84 offset:32768
    ds_read_b64_tr_b16 v[34:35], v84 offset:33280
    v_mfma_f32_16x16x32_bf16 v[76:79], v[68:71], v[36:39], v[76:79]
    s_waitcnt lgkmcnt(12)
    v_mfma_f32_32x32x16_bf16 v[16:31], v[40:43], v[152:155], v[16:31]
    ds_read_b64_tr_b16 v[36:37], v84 offset:34816
    ds_read_b64_tr_b16 v[38:39], v84 offset:35328
    v_mfma_f32_16x16x32_bf16 v[76:79], v[68:71], v[40:43], v[76:79]
    s_waitcnt lgkmcnt(12)
    v_mfma_f32_32x32x16_bf16 v[16:31], v[44:47], v[156:159], v[16:31]
    ds_read_b64_tr_b16 v[40:41], v84 offset:36864
    ds_read_b64_tr_b16 v[42:43], v84 offset:37376
    v_mfma_f32_16x16x32_bf16 v[76:79], v[68:71], v[44:47], v[76:79]
    s_waitcnt lgkmcnt(12)
    v_mfma_f32_32x32x16_bf16 v[16:31], v[48:51], v[160:163], v[16:31]
    ds_read_b64_tr_b16 v[44:45], v84 offset:38912
    ds_read_b64_tr_b16 v[46:47], v84 offset:39424
    v_mfma_f32_16x16x32_bf16 v[76:79], v[68:71], v[48:51], v[76:79]
    s_waitcnt vmcnt(0)
    s_mov_b64 exec, 1
    ds_add_rtn_u32 v5, v251, v252 offset:40
    s_waitcnt lgkmcnt(0)
    v_cmp_eq_u32 vcc, 3, v5
    s_cbranch_vccz Lpush_16
    s_mov_b32 exec_lo, 0xf
    buffer_store_dword v2, v81, s[32:35], s54 offen sc1
Lpush_16:
    s_mov_b64 exec, -1
    s_waitcnt lgkmcnt(12)
    v_mfma_f32_32x32x16_bf16 v[16:31], v[52:55], v[164:167], v[16:31]
    ds_read_b64_tr_b16 v[48:49], v84 offset:40960
    ds_read_b64_tr_b16 v[50:51], v84 offset:41472
    v_mfma_f32_16x16x32_bf16 v[76:79], v[68:71], v[52:55], v[76:79]
    s_waitcnt lgkmcnt(12)
    v_mfma_f32_32x32x16_bf16 v[16:31], v[56:59], v[168:171], v[16:31]
    ds_read_b64_tr_b16 v[52:53], v84 offset:43008
    ds_read_b64_tr_b16 v[54:55], v84 offset:43520
    v_mfma_f32_16x16x32_bf16 v[76:79], v[68:71], v[56:59], v[76:79]
    s_waitcnt lgkmcnt(12)
    v_mfma_f32_32x32x16_bf16 v[16:31], v[60:63], v[172:175], v[16:31]
    ds_read_b64_tr_b16 v[56:57], v84 offset:45056
    ds_read_b64_tr_b16 v[58:59], v84 offset:45568
    v_mfma_f32_16x16x32_bf16 v[76:79], v[68:71], v[60:63], v[76:79]
    s_waitcnt lgkmcnt(12)
    v_mfma_f32_32x32x16_bf16 v[16:31], v[32:35], v[176:179], v[16:31]
    ds_read_b64_tr_b16 v[60:61], v84 offset:47104
    ds_read_b64_tr_b16 v[62:63], v84 offset:47616
    v_mfma_f32_16x16x32_bf16 v[76:79], v[68:71], v[32:35], v[76:79]
    s_waitcnt lgkmcnt(12)
    v_mfma_f32_32x32x16_bf16 v[16:31], v[36:39], v[180:183], v[16:31]
    ds_read_b64_tr_b16 v[32:33], v84 offset:49152
    ds_read_b64_tr_b16 v[34:35], v84 offset:49664
    v_mfma_f32_16x16x32_bf16 v[76:79], v[68:71], v[36:39], v[76:79]
    s_waitcnt lgkmcnt(12)
    v_mfma_f32_32x32x16_bf16 v[16:31], v[40:43], v[184:187], v[16:31]
    ds_read_b64_tr_b16 v[36:37], v84 offset:51200
    ds_read_b64_tr_b16 v[38:39], v84 offset:51712
    v_mfma_f32_16x16x32_bf16 v[76:79], v[68:71], v[40:43], v[76:79]
    s_waitcnt lgkmcnt(12)
    v_mfma_f32_32x32x16_bf16 v[16:31], v[44:47], v[188:191], v[16:31]
    ds_read_b64_tr_b16 v[40:41], v84 offset:53248
    ds_read_b64_tr_b16 v[42:43], v84 offset:53760
    v_mfma_f32_16x16x32_bf16 v[76:79], v[68:71], v[44:47], v[76:79]
    s_waitcnt lgkmcnt(12)
    v_mfma_f32_32x32x16_bf16 v[16:31], v[48:51], v[192:195], v[16:31]
    ds_read_b64_tr_b16 v[44:45], v84 offset:55296
    ds_read_b64_tr_b16 v[46:47], v84 offset:55808
    v_mfma_f32_16x16x32_bf16 v[76:79], v[68:71], v[48:51], v[76:79]
    s_waitcnt lgkmcnt(12)
    v_mfma_f32_32x32x16_bf16 v[16:31], v[52:55], v[196:199], v[16:31]
    ds_read_b64_tr_b16 v[48:49], v84 offset:57344
    ds_read_b64_tr_b16 v[50:51], v84 offset:57856
    v_mfma_f32_16x16x32_bf16 v[76:79], v[68:71], v[52:55], v[76:79]
    s_waitcnt lgkmcnt(12)
    v_mfma_f32_32x32x16_bf16 v[16:31], v[56:59], v[200:203], v[16:31]
    ds_read_b64_tr_b16 v[52:53], v84 offset:59392
    ds_read_b64_tr_b16 v[54:55], v84 offset:59904
    v_mfma_f32_16x16x32_bf16 v[76:79], v[68:71], v[56:59], v[76:79]
    s_waitcnt lgkmcnt(12)
    v_mfma_f32_32x32x16_bf16 v[16:31], v[60:63], v[204:207], v[16:31]
    ds_read_b64_tr_b16 v[56:57], v84 offset:61440
    ds_read_b64_tr_b16 v[58:59], v84 offset:61952
    v_mfma_f32_16x16x32_bf16 v[76:79], v[68:71], v[60:63], v[76:79]
    s_waitcnt lgkmcnt(12)
    v_mfma_f32_32x32x16_bf16 v[16:31], v[32:35], v[208:211], v[16:31]
    ds_read_b64_tr_b16 v[60:61], v84 offset:63488
    ds_read_b64_tr_b16 v[62:63], v84 offset:64000
    v_mfma_f32_16x16x32_bf16 v[76:79], v[68:71], v[32:35], v[76:79]
    s_waitcnt lgkmcnt(12)
    v_mfma_f32_32x32x16_bf16 v[16:31], v[36:39], v[212:215], v[16:31]
    v_mfma_f32_16x16x32_bf16 v[76:79], v[68:71], v[36:39], v[76:79]
    s_waitcnt lgkmcnt(10)
    v_mfma_f32_32x32x16_bf16 v[16:31], v[40:43], v[216:219], v[16:31]
    v_mfma_f32_16x16x32_bf16 v[76:79], v[68:71], v[40:43], v[76:79]
    s_waitcnt lgkmcnt(8)
    v_mfma_f32_32x32x16_bf16 v[16:31], v[44:47], v[220:223], v[16:31]
    v_mfma_f32_16x16x32_bf16 v[76:79], v[68:71], v[44:47], v[76:79]
    s_waitcnt lgkmcnt(6)
    v_mfma_f32_32x32x16_bf16 v[16:31], v[48:51], v[224:227], v[16:31]
    v_mfma_f32_16x16x32_bf16 v[76:79], v[68:71], v[48:51], v[76:79]
    s_waitcnt lgkmcnt(4)
    v_mfma_f32_32x32x16_bf16 v[16:31], v[52:55], v[228:231], v[16:31]
    v_mfma_f32_16x16x32_bf16 v[76:79], v[68:71], v[52:55], v[76:79]
    s_waitcnt lgkmcnt(2)
    v_mfma_f32_32x32x16_bf16 v[16:31], v[56:59], v[232:235], v[16:31]
    v_mfma_f32_16x16x32_bf16 v[76:79], v[68:71], v[56:59], v[76:79]
    s_waitcnt lgkmcnt(0)
    v_mfma_f32_32x32x16_bf16 v[16:31], v[60:63], v[236:239], v[16:31]
    v_mfma_f32_16x16x32_bf16 v[76:79], v[68:71], v[60:63], v[76:79]
    s_mov_b32 s50, 0xffff
    s_mov_b64 exec, 1
    ds_add_u32 v251, v252 offset:36
    s_mov_b64 exec, -1
    v_mul_f32 v86, 0x3eb8aa3b, v86
    s_nop 2
    v_cvt_pk_bf16_f32 v73, v76, v76
    v_and_b32 v6, 0xffff0000, v73
    v_sub_f32 v6, v76, v6
    v_cvt_pk_bf16_f32 v6, v6, v6
    v_bfi_b32 v72, s50, v73, v6
    s_nop 1
    v_mfma_f32_32x32x16_bf16 v[16:31], v[72:75], v[64:67], v[16:31]
    s_xor_b32 s51, s58, 1
    s_lshl_b32 s51, s51, 1
    s_add_u32 s51, s51, s59
    s_mul_i32 s51, s51, 4128
    s_add_u32 s51, s51, 81280
    v_add_u32 v208, s51, v1
    v_and_b32 v5, 16, v3
    v_cmp_eq_u32 vcc, 0, v5
    s_add_u32 s51, s51, 1024
    v_mov_b32 v5, s51
    v_cndmask_b32 v209, v5, v208, vcc
    v_cndmask_b32 v210, v208, v5, vcc
    v_mov_b32 v221, 0xff800000
    v_mov_b32 v212, v221
    v_mov_b32 v214, v221
    v_pk_mul_f32 v[16:17], v[16:17], v[86:87] op_sel_hi:[1,0]
    v_pk_mul_f32 v[18:19], v[18:19], v[86:87] op_sel_hi:[1,0]
    v_pk_mul_f32 v[20:21], v[20:21], v[86:87] op_sel_hi:[1,0]
    v_pk_mul_f32 v[22:23], v[22:23], v[86:87] op_sel_hi:[1,0]
    v_pk_mul_f32 v[24:25], v[24:25], v[86:87] op_sel_hi:[1,0]
    v_pk_mul_f32 v[26:27], v[26:27], v[86:87] op_sel_hi:[1,0]
    v_pk_mul_f32 v[28:29], v[28:29], v[86:87] op_sel_hi:[1,0]
    v_pk_mul_f32 v[30:31], v[30:31], v[86:87] op_sel_hi:[1,0]
    v_cvt_pk_bf16_f32 v8, v16, v17
    v_cvt_pk_bf16_f32 v9, v18, v19
    v_cvt_pk_bf16_f32 v10, v20, v21
    v_cvt_pk_bf16_f32 v11, v22, v23
    v_cvt_pk_bf16_f32 v12, v24, v25
    v_cvt_pk_bf16_f32 v13, v26, v27
    v_cvt_pk_bf16_f32 v14, v28, v29
    v_cvt_pk_bf16_f32 v15, v30, v31
    s_min_u32 s56, s62, 8
    s_mul_i32 s57, s56, 8256
    s_sub_u32 s57, s57, 16512
    s_mov_b32 s55, 0
LE1:
    ds_read_b128 v[144:147], v208 offset:0
    ds_read_b128 v[148:151], v208 offset:1024
    ds_read_b128 v[152:155], v209 offset:2048
    ds_read_b128 v[156:159], v209 offset:3088
    v_add_u32 v216, s57, v209
    ds_read_b128 v[160:163], v210 offset:2048
    ds_read_b128 v[164:167], v210 offset:3088
    v_add_u32 v217, s57, v210
    v_add_u32 v211, s57, v208
    s_waitcnt lgkmcnt(4)
    v_mfma_f32_32x32x16_bf16 v[16:31], v[144:147], v[8:11], 0
    v_mfma_f32_32x32x16_bf16 v[32:47], v[148:151], v[12:15], 0
    v_and_b32 v5, 31, v3
    v_lshrrev_b32 v6, 5, v3
    v_lshlrev_b32 v6, 2, v6
    v_sub_u32 v5, v5, v6
    v_cmp_le_i32 s[64:65], 0, v5
    v_cmp_le_i32 s[66:67], 1, v5
    v_cmp_le_i32 s[68:69], 2, v5
    v_cmp_le_i32 s[70:71], 3, v5
    v_cmp_le_i32 s[72:73], 8, v5
    v_cmp_le_i32 s[74:75], 9, v5
    v_cmp_le_i32 s[76:77], 10, v5
    v_cmp_le_i32 s[78:79], 11, v5
    v_cmp_le_i32 s[80:81], 16, v5
    v_cmp_le_i32 s[82:83], 17, v5
    v_cmp_le_i32 s[84:85], 18, v5
    v_cmp_le_i32 s[86:87], 19, v5
    v_cmp_le_i32 s[88:89], 24, v5
    v_cmp_le_i32 s[90:91], 25, v5
    v_cmp_le_i32 s[92:93], 26, v5
    v_cmp_le_i32 s[94:95], 27, v5
    v_cndmask_b32 v16, v221, v16, s[64:65]
    v_cndmask_b32 v17, v221, v17, s[66:67]
    v_cndmask_b32 v18, v221, v18, s[68:69]
    v_cndmask_b32 v19, v221, v19, s[70:71]
    v_cndmask_b32 v20, v221, v20, s[72:73]
    v_cndmask_b32 v21, v221, v21, s[74:75]
    v_cndmask_b32 v22, v221, v22, s[76:77]
    v_cndmask_b32 v23, v221, v23, s[78:79]
    v_cndmask_b32 v24, v221, v24, s[80:81]
    v_cndmask_b32 v25, v221, v25, s[82:83]
    v_cndmask_b32 v26, v221, v26, s[84:85]
    v_cndmask_b32 v27, v221, v27, s[86:87]
    v_cndmask_b32 v28, v221, v28, s[88:89]
    v_cndmask_b32 v29, v221, v29, s[90:91]
    v_cndmask_b32 v30, v221, v30, s[92:93]
    v_cndmask_b32 v31, v221, v31, s[94:95]
    v_max3_f32 v212, v16, v17, v212
    v_max3_f32 v212, v18, v19, v212
    v_max3_f32 v212, v20, v21, v212
    v_max3_f32 v212, v22, v23, v212
    v_max3_f32 v212, v24, v25, v212
    v_max3_f32 v212, v26, v27, v212
    v_max3_f32 v212, v28, v29, v212
    v_max3_f32 v212, v30, v31, v212
    v_mov_b32 v5, v212
    s_nop 1
    v_permlane32_swap_b32 v212, v5
    v_max_f32 v212, v212, v5
    v_cndmask_b32 v32, v221, v32, s[64:65]
    v_cndmask_b32 v33, v221, v33, s[66:67]
    v_cndmask_b32 v34, v221, v34, s[68:69]
    v_cndmask_b32 v35, v221, v35, s[70:71]
    v_cndmask_b32 v36, v221, v36, s[72:73]
    v_cndmask_b32 v37, v221, v37, s[74:75]
    v_cndmask_b32 v38, v221, v38, s[76:77]
    v_cndmask_b32 v39, v221, v39, s[78:79]
    v_cndmask_b32 v40, v221, v40, s[80:81]
    v_cndmask_b32 v41, v221, v41, s[82:83]
    v_cndmask_b32 v42, v221, v42, s[84:85]
    v_cndmask_b32 v43, v221, v43, s[86:87]
    v_cndmask_b32 v44, v221, v44, s[88:89]
    v_cndmask_b32 v45, v221, v45, s[90:91]
    v_cndmask_b32 v46, v221, v46, s[92:93]
    v_cndmask_b32 v47, v221, v47, s[94:95]
    v_max3_f32 v214, v32, v33, v214
    v_max3_f32 v214, v34, v35, v214
    v_max3_f32 v214, v36, v37, v214
    v_max3_f32 v214, v38, v39, v214
    v_max3_f32 v214, v40, v41, v214
    v_max3_f32 v214, v42, v43, v214
    v_max3_f32 v214, v44, v45, v214
    v_max3_f32 v214, v46, v47, v214
    v_mov_b32 v5, v214
    s_nop 1
    v_permlane32_swap_b32 v214, v5
    v_max_f32 v214, v214, v5
    v_sub_f32 v48, 0, v212
    v_mov_b32 v49, v48
    v_mov_b64 v[50:51], v[48:49]
    v_mov_b64 v[52:53], v[48:49]
    v_mov_b64 v[54:55], v[48:49]
    v_mov_b64 v[56:57], v[48:49]
    v_mov_b64 v[58:59], v[48:49]
    v_mov_b64 v[60:61], v[48:49]
    v_mov_b64 v[62:63], v[48:49]
    v_sub_f32 v128, 0, v214
    v_mov_b32 v129, v128
    v_mov_b64 v[130:131], v[128:129]
    v_mov_b64 v[132:133], v[128:129]
    v_mov_b64 v[134:135], v[128:129]
    v_mov_b64 v[136:137], v[128:129]
    v_mov_b64 v[138:139], v[128:129]
    v_mov_b64 v[140:141], v[128:129]
    v_mov_b64 v[142:143], v[128:129]
    s_cmp_lt_u32 s46, 4
    s_cselect_b64 vcc, -1, 0
    v_cndmask_b32 v6, v221, v48, vcc
    v_cndmask_b32 v7, v221, v128, vcc
    v_cndmask_b32 v112, v48, v6, s[64:65]
    v_cndmask_b32 v113, v48, v6, s[66:67]
    v_cndmask_b32 v114, v48, v6, s[68:69]
    v_cndmask_b32 v115, v48, v6, s[70:71]
    v_cndmask_b32 v116, v48, v6, s[72:73]
    v_cndmask_b32 v117, v48, v6, s[74:75]
    v_cndmask_b32 v118, v48, v6, s[76:77]
    v_cndmask_b32 v119, v48, v6, s[78:79]
    v_cndmask_b32 v120, v48, v6, s[80:81]
    v_cndmask_b32 v121, v48, v6, s[82:83]
    v_cndmask_b32 v122, v48, v6, s[84:85]
    v_cndmask_b32 v123, v48, v6, s[86:87]
    v_cndmask_b32 v124, v48, v6, s[88:89]
    v_cndmask_b32 v125, v48, v6, s[90:91]
    v_cndmask_b32 v126, v48, v6, s[92:93]
    v_cndmask_b32 v127, v48, v6, s[94:95]
    v_cndmask_b32 v64, v128, v7, s[64:65]
    v_cndmask_b32 v65, v128, v7, s[66:67]
    v_cndmask_b32 v66, v128, v7, s[68:69]
    v_cndmask_b32 v67, v128, v7, s[70:71]
    v_cndmask_b32 v68, v128, v7, s[72:73]
    v_cndmask_b32 v69, v128, v7, s[74:75]
    v_cndmask_b32 v70, v128, v7, s[76:77]
    v_cndmask_b32 v71, v128, v7, s[78:79]
    v_cndmask_b32 v72, v128, v7, s[80:81]
    v_cndmask_b32 v73, v128, v7, s[82:83]
    v_cndmask_b32 v74, v128, v7, s[84:85]
    v_cndmask_b32 v75, v128, v7, s[86:87]
    v_cndmask_b32 v76, v128, v7, s[88:89]
    v_cndmask_b32 v77, v128, v7, s[90:91]
    v_cndmask_b32 v78, v128, v7, s[92:93]
    v_cndmask_b32 v79, v128, v7, s[94:95]
    v_pk_add_f32 v[16:17], v[16:17], v[48:49]
    v_pk_add_f32 v[18:19], v[18:19], v[48:49]
    v_pk_add_f32 v[20:21], v[20:21], v[48:49]
    v_pk_add_f32 v[22:23], v[22:23], v[48:49]
    v_pk_add_f32 v[24:25], v[24:25], v[48:49]
    v_pk_add_f32 v[26:27], v[26:27], v[48:49]
    v_pk_add_f32 v[28:29], v[28:29], v[48:49]
    v_pk_add_f32 v[30:31], v[30:31], v[48:49]
    v_exp_f32 v16, v16
    v_exp_f32 v17, v17
    v_exp_f32 v18, v18
    v_exp_f32 v19, v19
    v_exp_f32 v20, v20
    v_exp_f32 v21, v21
    v_exp_f32 v22, v22
    v_exp_f32 v23, v23
    v_exp_f32 v24, v24
    v_exp_f32 v25, v25
    v_exp_f32 v26, v26
    v_exp_f32 v27, v27
    v_exp_f32 v28, v28
    v_exp_f32 v29, v29
    v_exp_f32 v30, v30
    v_exp_f32 v31, v31
    v_cvt_pk_bf16_f32 v168, v16, v17
    v_cvt_pk_bf16_f32 v169, v18, v19
    v_cvt_pk_bf16_f32 v170, v20, v21
    v_cvt_pk_bf16_f32 v171, v22, v23
    v_cvt_pk_bf16_f32 v172, v24, v25
    v_cvt_pk_bf16_f32 v173, v26, v27
    v_cvt_pk_bf16_f32 v174, v28, v29
    v_cvt_pk_bf16_f32 v175, v30, v31
    v_pk_add_f32 v[32:33], v[32:33], v[128:129]
    v_pk_add_f32 v[34:35], v[34:35], v[128:129]
    v_pk_add_f32 v[36:37], v[36:37], v[128:129]
    v_pk_add_f32 v[38:39], v[38:39], v[128:129]
    v_pk_add_f32 v[40:41], v[40:41], v[128:129]
    v_pk_add_f32 v[42:43], v[42:43], v[128:129]
    v_pk_add_f32 v[44:45], v[44:45], v[128:129]
    v_pk_add_f32 v[46:47], v[46:47], v[128:129]
    v_exp_f32 v32, v32
    v_exp_f32 v33, v33
    v_exp_f32 v34, v34
    v_exp_f32 v35, v35
    v_exp_f32 v36, v36
    v_exp_f32 v37, v37
    v_exp_f32 v38, v38
    v_exp_f32 v39, v39
    v_exp_f32 v40, v40
    v_exp_f32 v41, v41
    v_exp_f32 v42, v42
    v_exp_f32 v43, v43
    v_exp_f32 v44, v44
    v_exp_f32 v45, v45
    v_exp_f32 v46, v46
    v_exp_f32 v47, v47
    v_cvt_pk_bf16_f32 v176, v32, v33
    v_cvt_pk_bf16_f32 v177, v34, v35
    v_cvt_pk_bf16_f32 v178, v36, v37
    v_cvt_pk_bf16_f32 v179, v38, v39
    v_cvt_pk_bf16_f32 v180, v40, v41
    v_cvt_pk_bf16_f32 v181, v42, v43
    v_cvt_pk_bf16_f32 v182, v44, v45
    v_cvt_pk_bf16_f32 v183, v46, v47
    s_waitcnt lgkmcnt(0)
    v_mfma_f32_32x32x16_bf16 v[80:95], v[152:155], v[168:171], 0
    v_mov_b64 v[96:97], 0
    v_mov_b64 v[98:99], 0
    v_mov_b64 v[100:101], 0
    v_mov_b64 v[102:103], 0
    v_mov_b64 v[104:105], 0
    v_mov_b64 v[106:107], 0
    v_mov_b64 v[108:109], 0
    v_mov_b64 v[110:111], 0
    v_mfma_f32_32x32x16_bf16 v[80:95], v[156:159], v[172:175], v[80:95]
    s_cmp_eq_u32 s56, 0
    s_cbranch_scc1 Lpass2done
    s_cmp_ge_u32 s46, 4
    s_cbranch_scc1 LH0
    s_mov_b32 s99, 20000000
Lspin_17:
    ds_read_b32 v5, v251 offset:32
    s_waitcnt lgkmcnt(0)
    v_cmp_gt_u32 vcc, 8, v5
    s_sub_u32 s99, s99, 1
    s_cbranch_scc1 Lspin_17x
    s_cbranch_vccnz Lspin_17
Lspin_17x:
LH0:
    s_mov_b32 s99, 20000000
Lspin_18:
    ds_read_b32 v5, v251 offset:112
    s_waitcnt lgkmcnt(0)
    v_cmp_gt_u32 vcc, 4, v5
    s_sub_u32 s99, s99, 1
    s_cbranch_scc1 Lspin_18x
    s_cbranch_vccnz Lspin_18
Lspin_18x:
    ds_read_b128 v[144:147], v211 offset:16512
    ds_read_b128 v[148:151], v211 offset:17536
    s_sub_u32 s50, s56, 1
    s_mov_b32 s51, 8256
    s_waitcnt lgkmcnt(1)
    v_mfma_f32_32x32x16_bf16 v[16:31], v[144:147], v[8:11], v[112:127]
    ds_read_b128 v[144:147], v211 offset:8256
    ds_read_b128 v[152:155], v216 offset:18560
    ds_read_b128 v[156:159], v216 offset:19600
    s_waitcnt lgkmcnt(3)
    v_mfma_f32_32x32x16_bf16 v[32:47], v[148:151], v[12:15], v[64:79]
    ds_read_b128 v[148:151], v211 offset:9280
    s_nop 5
    v_exp_f32 v16, v16
    v_exp_f32 v17, v17
    v_exp_f32 v18, v18
    v_exp_f32 v19, v19
    v_mfma_f32_32x32x16_bf16 v[96:111], v[160:163], v[176:179], v[96:111]
    v_exp_f32 v20, v20
    v_exp_f32 v21, v21
    v_exp_f32 v22, v22
    v_exp_f32 v23, v23
    v_mfma_f32_32x32x16_bf16 v[96:111], v[164:167], v[180:183], v[96:111]
    ds_read_b128 v[160:163], v217 offset:18560
    ds_read_b128 v[164:167], v217 offset:19600
    v_exp_f32 v24, v24
    v_exp_f32 v25, v25
    v_exp_f32 v26, v26
    v_exp_f32 v27, v27
    v_exp_f32 v28, v28
    v_exp_f32 v29, v29
    v_exp_f32 v30, v30
    v_exp_f32 v31, v31
    v_cvt_pk_bf16_f32 v168, v16, v17
    v_cvt_pk_bf16_f32 v169, v18, v19
    v_cvt_pk_bf16_f32 v170, v20, v21
    v_cvt_pk_bf16_f32 v171, v22, v23
    v_cvt_pk_bf16_f32 v172, v24, v25
    v_cvt_pk_bf16_f32 v173, v26, v27
    v_cvt_pk_bf16_f32 v174, v28, v29
    v_cvt_pk_bf16_f32 v175, v30, v31
    s_waitcnt lgkmcnt(3)
    v_mfma_f32_32x32x16_bf16 v[16:31], v[144:147], v[8:11], v[48:63]
    ds_read_b128 v[144:147], v211 offset:0
    v_exp_f32 v32, v32
    v_exp_f32 v33, v33
    v_exp_f32 v34, v34
    v_exp_f32 v35, v35
    v_mfma_f32_32x32x16_bf16 v[80:95], v[152:155], v[168:171], v[80:95]
    v_exp_f32 v36, v36
    v_exp_f32 v37, v37
    v_exp_f32 v38, v38
    v_exp_f32 v39, v39
    v_mfma_f32_32x32x16_bf16 v[80:95], v[156:159], v[172:175], v[80:95]
    ds_read_b128 v[152:155], v216 offset:10304
    ds_read_b128 v[156:159], v216 offset:11344
    v_exp_f32 v40, v40
    v_exp_f32 v41, v41
    v_exp_f32 v42, v42
    v_exp_f32 v43, v43
    v_exp_f32 v44, v44
    v_exp_f32 v45, v45
    v_exp_f32 v46, v46
    v_exp_f32 v47, v47
    s_mov_b32 s99, 20000000
Lspin_19:
    ds_read_b32 v5, v251 offset:32
    s_waitcnt lgkmcnt(0)
    v_cmp_gt_u32 vcc, 8, v5
    s_sub_u32 s99, s99, 1
    s_cbranch_scc1 Lspin_19x
    s_cbranch_vccnz Lspin_19
Lspin_19x:
    v_subrev_u32 v211, s51, v211
    v_subrev_u32 v216, s51, v216
    v_subrev_u32 v217, s51, v217
    s_sub_u32 s50, s50, 1
    v_cvt_pk_bf16_f32 v176, v32, v33
    v_cvt_pk_bf16_f32 v177, v34, v35
    v_cvt_pk_bf16_f32 v178, v36, v37
    v_cvt_pk_bf16_f32 v179, v38, v39
    v_cvt_pk_bf16_f32 v180, v40, v41
    v_cvt_pk_bf16_f32 v181, v42, v43
    v_cvt_pk_bf16_f32 v182, v44, v45
    v_cvt_pk_bf16_f32 v183, v46, v47
    s_cbranch_scc1 Lpass2done
Lpass2:
    s_waitcnt lgkmcnt(3)
    v_mfma_f32_32x32x16_bf16 v[32:47], v[148:151], v[12:15], v[128:143]
Lpass2e:
    ds_read_b128 v[148:151], v211 offset:9280
    v_exp_f32 v16, v16
    v_exp_f32 v17, v17
    v_exp_f32 v18, v18
    v_exp_f32 v19, v19
    v_mfma_f32_32x32x16_bf16 v[96:111], v[160:163], v[176:179], v[96:111]
    v_exp_f32 v20, v20
    v_exp_f32 v21, v21
    v_exp_f32 v22, v22
    v_exp_f32 v23, v23
    v_mfma_f32_32x32x16_bf16 v[96:111], v[164:167], v[180:183], v[96:111]
    ds_read_b128 v[160:163], v217 offset:18560
    ds_read_b128 v[164:167], v217 offset:19600
    v_exp_f32 v24, v24
    v_exp_f32 v25, v25
    v_exp_f32 v26, v26
    v_exp_f32 v27, v27
    v_exp_f32 v28, v28
    v_exp_f32 v29, v29
    v_exp_f32 v30, v30
    v_exp_f32 v31, v31
    v_cvt_pk_bf16_f32 v168, v16, v17
    v_cvt_pk_bf16_f32 v169, v18, v19
    v_cvt_pk_bf16_f32 v170, v20, v21
    v_cvt_pk_bf16_f32 v171, v22, v23
    v_cvt_pk_bf16_f32 v172, v24, v25
    v_cvt_pk_bf16_f32 v173, v26, v27
    v_cvt_pk_bf16_f32 v174, v28, v29
    v_cvt_pk_bf16_f32 v175, v30, v31
    s_waitcnt lgkmcnt(3)
    v_mfma_f32_32x32x16_bf16 v[16:31], v[144:147], v[8:11], v[48:63]
    ds_read_b128 v[144:147], v211 offset:0
    v_exp_f32 v32, v32
    v_exp_f32 v33, v33
    v_exp_f32 v34, v34
    v_exp_f32 v35, v35
    v_mfma_f32_32x32x16_bf16 v[80:95], v[152:155], v[168:171], v[80:95]
    v_exp_f32 v36, v36
    v_exp_f32 v37, v37
    v_exp_f32 v38, v38
    v_exp_f32 v39, v39
    v_mfma_f32_32x32x16_bf16 v[80:95], v[156:159], v[172:175], v[80:95]
    ds_read_b128 v[152:155], v216 offset:10304
    ds_read_b128 v[156:159], v216 offset:11344
    v_exp_f32 v40, v40
    v_exp_f32 v41, v41
    v_exp_f32 v42, v42
    v_exp_f32 v43, v43
    v_exp_f32 v44, v44
    v_exp_f32 v45, v45
    v_exp_f32 v46, v46
    v_exp_f32 v47, v47
    v_subrev_u32 v211, s51, v211
    v_subrev_u32 v216, s51, v216
    v_subrev_u32 v217, s51, v217
    s_sub_u32 s50, s50, 1
    v_cvt_pk_bf16_f32 v176, v32, v33
    v_cvt_pk_bf16_f32 v177, v34, v35
    v_cvt_pk_bf16_f32 v178, v36, v37
    v_cvt_pk_bf16_f32 v179, v38, v39
    v_cvt_pk_bf16_f32 v180, v40, v41
    v_cvt_pk_bf16_f32 v181, v42, v43
    v_cvt_pk_bf16_f32 v182, v44, v45
    v_cvt_pk_bf16_f32 v183, v46, v47
    s_cbranch_scc0 Lpass2
Lpass2done:
    s_waitcnt lgkmcnt(0)
    v_mfma_f32_32x32x16_bf16 v[96:111], v[160:163], v[176:179], v[96:111]
    v_mfma_f32_32x32x16_bf16 v[96:111], v[164:167], v[180:183], v[96:111]
    s_lshl_b32 s50, s63, 11
    s_add_u32 s50, s50, 6291456
    s_mov_b32 s51, 0x53800000
    s_nop 3
    v_cmp_nlt_f32 s[52:53], v88, s51
    v_rcp_f32 v88, v88
    s_nop 0
    v_mul_f32 v80, v88, v80
    v_mul_f32 v81, v88, v81
    v_mul_f32 v82, v88, v82
    v_mul_f32 v83, v88, v83
    v_mul_f32 v84, v88, v84
    v_mul_f32 v85, v88, v85
    v_mul_f32 v86, v88, v86
    v_mul_f32 v87, v88, v87
    v_cvt_pk_bf16_f32 v184, v80, v81
    v_cvt_pk_bf16_f32 v185, v82, v83
    v_cvt_pk_bf16_f32 v186, v84, v85
    v_cvt_pk_bf16_f32 v187, v86, v87
    v_cmp_nlt_f32 vcc, v96, s51
    v_rcp_f32 v96, v96
    s_or_b64 vcc, vcc, s[52:53]
    s_cbranch_scc1 Lfallback
Lfbret:
    buffer_store_dwordx4 v[184:187], v1, s[32:35], s50 offen sc1
    v_pk_mul_f32 v[104:105], v[104:105], v[96:97] op_sel_hi:[1,0]
    v_pk_mul_f32 v[106:107], v[106:107], v[96:97] op_sel_hi:[1,0]
    v_pk_mul_f32 v[108:109], v[108:109], v[96:97] op_sel_hi:[1,0]
    v_pk_mul_f32 v[110:111], v[110:111], v[96:97] op_sel_hi:[1,0]
    v_cvt_pk_bf16_f32 v188, v104, v105
    v_cvt_pk_bf16_f32 v189, v106, v107
    v_cvt_pk_bf16_f32 v190, v108, v109
    v_cvt_pk_bf16_f32 v191, v110, v111
    buffer_store_dwordx4 v[188:191], v1, s[32:35], s50 offen offset:1024 sc1
    s_mov_b64 exec, 1
    ds_add_u32 v251, v252 offset:0
    s_mov_b64 exec, -1
    v_lshrrev_b32 v6, 5, v3
    v_lshl_add_u32 v8, v6, 9, v248
    s_lshl_b32 s52, s59, 6
    v_xor_b32 v6, s52, v8
    s_mul_i32 s51, s59, 24576
    v_add_u32 v9, s51, v6
    v_xor_b32 v10, 64, v9
    s_mul_i32 s51, s59, 12288
    v_add_u32 v16, s51, v6
    v_xor_b32 v17, 64, v16
    v_lshlrev_b32 v15, 8, v3
    s_lshl_b32 s55, s46, 11
    s_lshl_b32 s51, s47, 2
    s_add_u32 s55, s55, s51
    s_add_u32 s50, s55, 65536
    s_mov_b32 s99, 20000000
Lspin_20:
    ds_read_b32 v5, v251 offset:108
    s_waitcnt lgkmcnt(0)
    v_cmp_gt_u32 vcc, 4, v5
    s_sub_u32 s99, s99, 1
    s_cbranch_scc1 Lspin_20x
    s_cbranch_vccnz Lspin_20
Lspin_20x:
    ds_read_b64_tr_b16 v[112:113], v9 offset:0
    ds_read_b64_tr_b16 v[114:115], v9 offset:1024
    ds_read_b64_tr_b16 v[116:117], v10 offset:0
    ds_read_b64_tr_b16 v[118:119], v10 offset:1024
    ds_read_b64_tr_b16 v[120:121], v9 offset:2048
    ds_read_b64_tr_b16 v[122:123], v9 offset:3072
    ds_read_b64_tr_b16 v[124:125], v10 offset:2048
    ds_read_b64_tr_b16 v[126:127], v10 offset:3072
    ds_read_b64_tr_b16 v[128:129], v9 offset:4096
    ds_read_b64_tr_b16 v[130:131], v9 offset:5120
    ds_read_b64_tr_b16 v[132:133], v10 offset:4096
    ds_read_b64_tr_b16 v[134:135], v10 offset:5120
    ds_read_b64_tr_b16 v[136:137], v9 offset:6144
    ds_read_b64_tr_b16 v[138:139], v9 offset:7168
    ds_read_b64_tr_b16 v[140:141], v10 offset:6144
    ds_read_b64_tr_b16 v[142:143], v10 offset:7168
    ds_read_b64_tr_b16 v[144:145], v9 offset:8192
    ds_read_b64_tr_b16 v[146:147], v9 offset:9216
    ds_read_b64_tr_b16 v[148:149], v10 offset:8192
    ds_read_b64_tr_b16 v[150:151], v10 offset:9216
    ds_read_b64_tr_b16 v[152:153], v9 offset:10240
    ds_read_b64_tr_b16 v[154:155], v9 offset:11264
    ds_read_b64_tr_b16 v[156:157], v10 offset:10240
    ds_read_b64_tr_b16 v[158:159], v10 offset:11264
    ds_read_b64_tr_b16 v[160:161], v9 offset:12288
    ds_read_b64_tr_b16 v[162:163], v9 offset:13312
    ds_read_b64_tr_b16 v[164:165], v10 offset:12288
    ds_read_b64_tr_b16 v[166:167], v10 offset:13312
    ds_read_b64_tr_b16 v[168:169], v9 offset:14336
    ds_read_b64_tr_b16 v[170:171], v9 offset:15360
    ds_read_b64_tr_b16 v[172:173], v10 offset:14336
    ds_read_b64_tr_b16 v[174:175], v10 offset:15360
    ds_read_b64_tr_b16 v[176:177], v9 offset:16384
    ds_read_b64_tr_b16 v[178:179], v9 offset:17408
    ds_read_b64_tr_b16 v[180:181], v10 offset:16384
    ds_read_b64_tr_b16 v[182:183], v10 offset:17408
    ds_read_b64_tr_b16 v[184:185], v9 offset:18432
    ds_read_b64_tr_b16 v[186:187], v9 offset:19456
    ds_read_b64_tr_b16 v[188:189], v10 offset:18432
    ds_read_b64_tr_b16 v[190:191], v10 offset:19456
    s_waitcnt vmcnt(0)
    s_mov_b64 exec, 1
    ds_add_rtn_u32 v5, v251, v252 offset:44
    s_waitcnt lgkmcnt(0)
    v_cmp_eq_u32 vcc, 3, v5
    s_cbranch_vccz Lpush_21
    s_mov_b32 exec_lo, 0xff
    buffer_store_dword v2, v15, s[32:35], s50 offen sc1
Lpush_21:
    s_mov_b64 exec, -1
    ds_read_b64_tr_b16 v[192:193], v9 offset:20480
    ds_read_b64_tr_b16 v[194:195], v9 offset:21504
    ds_read_b64_tr_b16 v[196:197], v10 offset:20480
    ds_read_b64_tr_b16 v[198:199], v10 offset:21504
    ds_read_b64_tr_b16 v[200:201], v9 offset:22528
    ds_read_b64_tr_b16 v[202:203], v9 offset:23552
    ds_read_b64_tr_b16 v[204:205], v10 offset:22528
    ds_read_b64_tr_b16 v[206:207], v10 offset:23552
    ds_read_b64_tr_b16 v[208:209], v16 offset:49152
    ds_read_b64_tr_b16 v[210:211], v16 offset:55296
    ds_read_b64_tr_b16 v[212:213], v17 offset:49152
    ds_read_b64_tr_b16 v[214:215], v17 offset:55296
    ds_read_b64_tr_b16 v[216:217], v16 offset:50176
    ds_read_b64_tr_b16 v[218:219], v16 offset:56320
    ds_read_b64_tr_b16 v[220:221], v17 offset:50176
    ds_read_b64_tr_b16 v[222:223], v17 offset:56320
    ds_read_b64_tr_b16 v[224:225], v16 offset:51200
    ds_read_b64_tr_b16 v[226:227], v16 offset:57344
    ds_read_b64_tr_b16 v[228:229], v17 offset:51200
    ds_read_b64_tr_b16 v[230:231], v17 offset:57344
    ds_read_b64_tr_b16 v[232:233], v16 offset:52224
    ds_read_b64_tr_b16 v[234:235], v16 offset:58368
    ds_read_b64_tr_b16 v[236:237], v17 offset:52224
    ds_read_b64_tr_b16 v[238:239], v17 offset:58368
    s_lshl_b32 s54, s62, 1
    s_add_u32 s54, s54, s59
    s_lshl_b32 s54, s54, 14
    s_add_u32 s54, s54, 6291456
    s_mov_b32 s92, s54
    v_lshlrev_b32 v16, 16, v240
    v_and_b32 v17, 0xffff0000, v240
    v_lshlrev_b32 v18, 16, v241
    v_and_b32 v19, 0xffff0000, v241
    v_lshlrev_b32 v20, 16, v242
    v_and_b32 v21, 0xffff0000, v242
    v_lshlrev_b32 v22, 16, v243
    v_and_b32 v23, 0xffff0000, v243
    v_lshlrev_b32 v24, 16, v244
    v_and_b32 v25, 0xffff0000, v244
    v_lshlrev_b32 v26, 16, v245
    v_and_b32 v27, 0xffff0000, v245
    v_lshlrev_b32 v28, 16, v246
    v_and_b32 v29, 0xffff0000, v246
    v_lshlrev_b32 v30, 16, v247
    v_and_b32 v31, 0xffff0000, v247
    s_xor_b32 s50, s45, 2
    s_lshl_b32 s52, s50, 2
    v_add_u32 v13, s52, v251
    s_lshl_b32 s50, s50, 12
    v_add_u32 v11, s50, v1
    s_lshl_b32 s51, s45, 12
    v_add_u32 v12, s51, v1
    s_lshl_b32 s52, s45, 2
    v_add_u32 v14, s52, v251
    s_lshl_b32 s53, s59, 4
    s_add_u32 s53, s53, s7
    s_add_u32 s53, s53, 65536
    s_waitcnt lgkmcnt(0)
    s_mov_b64 exec, 1
    ds_add_u32 v251, v252 offset:4
    s_mov_b64 exec, -1
    s_mov_b32 s99, 400000
Lsp_22:
    s_sub_u32 s99, s99, 1
    s_cbranch_scc1 Lsp_22x
    s_buffer_load_dwordx4 s[80:83], s[32:35], s53 glc
    s_waitcnt lgkmcnt(0)
    s_cmp_eq_u64 s[80:81], s[0:1]
    s_cbranch_scc0 Lsp_22
    s_cmp_eq_u64 s[82:83], s[0:1]
    s_cbranch_scc0 Lsp_22
Lsp_22x:
    buffer_load_dwordx4 v[48:51], v1, s[32:35], s54 offen sc1
    buffer_load_dwordx4 v[52:55], v1, s[32:35], s54 offen offset:1024 sc1
    buffer_load_dwordx4 v[56:59], v1, s[32:35], s54 offen offset:2048 sc1
    buffer_load_dwordx4 v[60:63], v1, s[32:35], s54 offen offset:3072 sc1
    s_add_u32 s54, s54, 4096
    buffer_load_dwordx4 v[64:67], v1, s[32:35], s54 offen sc1
    buffer_load_dwordx4 v[68:71], v1, s[32:35], s54 offen offset:1024 sc1
    buffer_load_dwordx4 v[72:75], v1, s[32:35], s54 offen offset:2048 sc1
    buffer_load_dwordx4 v[76:79], v1, s[32:35], s54 offen offset:3072 sc1
    s_add_u32 s54, s54, 4096
    buffer_load_dwordx4 v[80:83], v1, s[32:35], s54 offen sc1
    buffer_load_dwordx4 v[84:87], v1, s[32:35], s54 offen offset:1024 sc1
    buffer_load_dwordx4 v[88:91], v1, s[32:35], s54 offen offset:2048 sc1
    buffer_load_dwordx4 v[92:95], v1, s[32:35], s54 offen offset:3072 sc1
    s_add_u32 s54, s54, 4096
    buffer_load_dwordx4 v[96:99], v1, s[32:35], s54 offen sc1
    buffer_load_dwordx4 v[100:103], v1, s[32:35], s54 offen offset:1024 sc1
    buffer_load_dwordx4 v[104:107], v1, s[32:35], s54 offen offset:2048 sc1
    buffer_load_dwordx4 v[108:111], v1, s[32:35], s54 offen offset:3072 sc1
    s_mov_b32 s99, 20000000
Lspin_23:
    ds_read_b32 v5, v251 offset:4
    s_waitcnt lgkmcnt(0)
    v_cmp_gt_u32 vcc, 4, v5
    s_sub_u32 s99, s99, 1
    s_cbranch_scc1 Lspin_23x
    s_cbranch_vccnz Lspin_23
Lspin_23x:
    s_waitcnt vmcnt(15)
    v_mfma_f32_32x32x16_bf16 v[32:47], v[116:119], v[48:51], 0
    v_mfma_f32_32x32x16_bf16 v[16:31], v[112:115], v[48:51], v[16:31]
    s_waitcnt vmcnt(14)
    v_mfma_f32_32x32x16_bf16 v[32:47], v[124:127], v[52:55], v[32:47]
    v_mfma_f32_32x32x16_bf16 v[16:31], v[120:123], v[52:55], v[16:31]
    s_waitcnt vmcnt(13)
    v_mfma_f32_32x32x16_bf16 v[32:47], v[132:135], v[56:59], v[32:47]
    v_mfma_f32_32x32x16_bf16 v[16:31], v[128:131], v[56:59], v[16:31]
    s_waitcnt vmcnt(12)
    v_mfma_f32_32x32x16_bf16 v[32:47], v[140:143], v[60:63], v[32:47]
    v_mfma_f32_32x32x16_bf16 v[16:31], v[136:139], v[60:63], v[16:31]
    s_waitcnt vmcnt(11)
    v_mfma_f32_32x32x16_bf16 v[32:47], v[148:151], v[64:67], v[32:47]
    v_mfma_f32_32x32x16_bf16 v[16:31], v[144:147], v[64:67], v[16:31]
    s_waitcnt vmcnt(10)
    v_mfma_f32_32x32x16_bf16 v[32:47], v[156:159], v[68:71], v[32:47]
    v_mfma_f32_32x32x16_bf16 v[16:31], v[152:155], v[68:71], v[16:31]
    s_waitcnt vmcnt(9)
    v_mfma_f32_32x32x16_bf16 v[32:47], v[164:167], v[72:75], v[32:47]
    v_mfma_f32_32x32x16_bf16 v[16:31], v[160:163], v[72:75], v[16:31]
    s_waitcnt vmcnt(8)
    v_mfma_f32_32x32x16_bf16 v[32:47], v[172:175], v[76:79], v[32:47]
    v_mfma_f32_32x32x16_bf16 v[16:31], v[168:171], v[76:79], v[16:31]
    s_waitcnt vmcnt(7)
    v_mfma_f32_32x32x16_bf16 v[32:47], v[180:183], v[80:83], v[32:47]
    v_mfma_f32_32x32x16_bf16 v[16:31], v[176:179], v[80:83], v[16:31]
    s_waitcnt vmcnt(6)
    v_mfma_f32_32x32x16_bf16 v[32:47], v[188:191], v[84:87], v[32:47]
    v_mfma_f32_32x32x16_bf16 v[16:31], v[184:187], v[84:87], v[16:31]
    s_waitcnt vmcnt(5)
    v_mfma_f32_32x32x16_bf16 v[32:47], v[196:199], v[88:91], v[32:47]
    v_mfma_f32_32x32x16_bf16 v[16:31], v[192:195], v[88:91], v[16:31]
    s_waitcnt vmcnt(4)
    v_mfma_f32_32x32x16_bf16 v[32:47], v[204:207], v[92:95], v[32:47]
    v_mfma_f32_32x32x16_bf16 v[16:31], v[200:203], v[92:95], v[16:31]
    s_waitcnt vmcnt(3)
    v_mfma_f32_32x32x16_bf16 v[32:47], v[212:215], v[96:99], v[32:47]
    s_waitcnt vmcnt(2)
    v_mfma_f32_32x32x16_bf16 v[32:47], v[220:223], v[100:103], v[32:47]
    s_waitcnt vmcnt(1)
    v_mfma_f32_32x32x16_bf16 v[32:47], v[228:231], v[104:107], v[32:47]
    s_waitcnt vmcnt(0)
    v_mfma_f32_32x32x16_bf16 v[32:47], v[236:239], v[108:111], v[32:47]
    s_lshl_b32 s54, s63, 9
    s_add_u32 s54, s54, 1048576
    v_mov_b32 v66, v2
    v_mov_b32 v67, v2
    v_mfma_f32_32x32x16_bf16 v[16:31], v[208:211], v[96:99], v[16:31]
    v_mfma_f32_32x32x16_bf16 v[16:31], v[216:219], v[100:103], v[16:31]
    s_nop 5
    ds_write_b128 v11, v[32:35] offset:0
    ds_write_b128 v11, v[36:39] offset:1024
    v_mfma_f32_32x32x16_bf16 v[16:31], v[224:227], v[104:107], v[16:31]
    ds_write_b128 v11, v[40:43] offset:2048
    ds_write_b128 v11, v[44:47] offset:3072
    v_mfma_f32_32x32x16_bf16 v[16:31], v[232:235], v[108:111], v[16:31]
    s_mov_b64 exec, 1
    ds_add_u32 v13, v252 offset:64
    s_mov_b64 exec, -1
    s_mov_b32 s99, 20000000
Lspin_24:
    ds_read_b32 v5, v14 offset:64
    s_waitcnt lgkmcnt(0)
    v_cmp_gt_u32 vcc, 1, v5
    s_sub_u32 s99, s99, 1
    s_cbranch_scc1 Lspin_24x
    s_cbranch_vccnz Lspin_24
Lspin_24x:
    ds_read_b128 v[48:51], v12 offset:0
    ds_read_b128 v[52:55], v12 offset:1024
    ds_read_b128 v[56:59], v12 offset:2048
    ds_read_b128 v[60:63], v12 offset:3072
    s_add_u32 s50, s55, 131072
    s_waitcnt lgkmcnt(0)
    v_pk_add_f32 v[16:17], v[16:17], v[48:49]
    v_pk_add_f32 v[18:19], v[18:19], v[50:51]
    v_pk_add_f32 v[20:21], v[20:21], v[52:53]
    v_pk_add_f32 v[22:23], v[22:23], v[54:55]
    v_pk_add_f32 v[24:25], v[24:25], v[56:57]
    v_pk_add_f32 v[26:27], v[26:27], v[58:59]
    v_pk_add_f32 v[28:29], v[28:29], v[60:61]
    v_pk_add_f32 v[30:31], v[30:31], v[62:63]
    v_pk_add_f32 v[68:69], v[16:17], v[18:19]
    v_pk_mul_f32 v[70:71], v[16:17], v[16:17]
    v_pk_fma_f32 v[70:71], v[18:19], v[18:19], v[70:71]
    v_pk_add_f32 v[68:69], v[68:69], v[20:21]
    v_pk_fma_f32 v[70:71], v[20:21], v[20:21], v[70:71]
    v_pk_add_f32 v[68:69], v[68:69], v[22:23]
    v_pk_fma_f32 v[70:71], v[22:23], v[22:23], v[70:71]
    v_pk_add_f32 v[68:69], v[68:69], v[24:25]
    v_pk_fma_f32 v[70:71], v[24:25], v[24:25], v[70:71]
    v_pk_add_f32 v[68:69], v[68:69], v[26:27]
    v_pk_fma_f32 v[70:71], v[26:27], v[26:27], v[70:71]
    v_pk_add_f32 v[68:69], v[68:69], v[28:29]
    v_pk_fma_f32 v[70:71], v[28:29], v[28:29], v[70:71]
    v_pk_add_f32 v[68:69], v[68:69], v[30:31]
    v_pk_fma_f32 v[70:71], v[30:31], v[30:31], v[70:71]
    v_add_f32 v64, v68, v69
    v_add_f32 v65, v70, v71
    v_mov_b64 v[68:69], v[64:65]
    s_nop 1
    v_permlane32_swap_b32 v64, v68
    v_permlane32_swap_b32 v65, v69
    v_pk_add_f32 v[64:65], v[64:65], v[68:69]
    s_mov_b32 exec_hi, 0
    buffer_store_dwordx4 v[64:67], v1, s[32:35], s54 offen sc1
    s_mov_b64 exec, 1
    ds_add_rtn_u32 v5, v251, v252 offset:48
    s_waitcnt lgkmcnt(0)
    v_cmp_eq_u32 vcc, 3, v5
    s_cbranch_vccz Lpush_25
    s_mov_b32 exec_lo, 0xff
    buffer_store_dword v2, v15, s[32:35], s50 offen sc1
Lpush_25:
    s_mov_b64 exec, -1
    s_cmp_eq_u32 s48, 15
    s_cbranch_scc1 LA4p1
    s_lshl_b32 s50, s48, 2
    s_add_u32 s50, s50, s45
    s_mul_i32 s56, s50, 98304
    s_add_u32 s56, s56, 12632064
    s_lshl_b32 s53, s45, 4
    s_add_u32 s53, s53, s98
    s_add_u32 s53, s53, 327688
    s_mov_b32 s99, 400000
Lsp_26:
    s_sub_u32 s99, s99, 1
    s_cbranch_scc1 Lsp_26x
    s_buffer_load_dwordx2 s[80:81], s[32:35], s53 glc
    s_waitcnt lgkmcnt(0)
    s_cmp_eq_u64 s[80:81], s[0:1]
    s_cbranch_scc0 Lsp_26
Lsp_26x:
    s_mov_b32 s6, s53
    buffer_load_dwordx4 v[104:107], v1, s[32:35], s56 offen sc1
    buffer_load_dwordx4 v[108:111], v1, s[32:35], s56 offen offset:1024 sc1
    buffer_load_dwordx4 v[112:115], v1, s[32:35], s56 offen offset:2048 sc1
    s_add_u32 s56, s56, 3072
    buffer_load_dwordx4 v[116:119], v1, s[32:35], s56 offen sc1
    buffer_load_dwordx4 v[120:123], v1, s[32:35], s56 offen offset:1024 sc1
    buffer_load_dwordx4 v[124:127], v1, s[32:35], s56 offen offset:2048 sc1
    s_add_u32 s56, s56, 3072
    buffer_load_dwordx4 v[128:131], v1, s[32:35], s56 offen sc1
    buffer_load_dwordx4 v[132:135], v1, s[32:35], s56 offen offset:1024 sc1
    buffer_load_dwordx4 v[136:139], v1, s[32:35], s56 offen offset:2048 sc1
    s_add_u32 s56, s56, 3072
    buffer_load_dwordx4 v[140:143], v1, s[32:35], s56 offen sc1
    buffer_load_dwordx4 v[144:147], v1, s[32:35], s56 offen offset:1024 sc1
    buffer_load_dwordx4 v[148:151], v1, s[32:35], s56 offen offset:2048 sc1
    s_add_u32 s56, s56, 3072
LA4p1:
    s_lshl_b32 s50, s62, 13
    s_add_u32 s50, s50, 1048576
    s_add_u32 s51, s50, 4096
    s_add_u32 s53, s7, 131072
    s_lshl_b32 s52, s45, 12
    v_lshrrev_b32 v9, 6, v250
    v_lshl_add_u32 v9, v9, 3, v250
    v_add_u32 v9, s52, v9
    v_lshrrev_b32 v10, 6, v249
    v_lshl_add_u32 v10, v10, 3, v249
    v_add_u32 v10, s52, v10
    s_mov_b32 s99, 400000
Lsp_27:
    s_sub_u32 s99, s99, 1
    s_cbranch_scc1 Lsp_27x
    s_buffer_load_dwordx8 s[80:87], s[32:35], s53 glc
    s_waitcnt lgkmcnt(0)
    s_cmp_eq_u64 s[80:81], s[0:1]
    s_cbranch_scc0 Lsp_27
    s_cmp_eq_u64 s[82:83], s[0:1]
    s_cbranch_scc0 Lsp_27
    s_cmp_eq_u64 s[84:85], s[0:1]
    s_cbranch_scc0 Lsp_27
    s_cmp_eq_u64 s[86:87], s[0:1]
    s_cbranch_scc0 Lsp_27
Lsp_27x:
    s_mov_b32 s99, 400000
Lspin_28:
    buffer_load_dwordx4 v[72:75], v1, s[32:35], s50 offen sc1
    buffer_load_dwordx4 v[76:79], v1, s[32:35], s50 offen offset:1024 sc1
    buffer_load_dwordx4 v[80:83], v1, s[32:35], s50 offen offset:2048 sc1
    buffer_load_dwordx4 v[84:87], v1, s[32:35], s50 offen offset:3072 sc1
    buffer_load_dwordx4 v[88:91], v1, s[32:35], s51 offen sc1
    buffer_load_dwordx4 v[92:95], v1, s[32:35], s51 offen offset:1024 sc1
    buffer_load_dwordx4 v[96:99], v1, s[32:35], s51 offen offset:2048 sc1
    buffer_load_dwordx4 v[100:103], v1, s[32:35], s51 offen offset:3072 sc1
    s_waitcnt vmcnt(7)
    v_xor_b32 v5, v2, v74
    s_waitcnt vmcnt(6)
    v_xor_b32 v6, v2, v78
    v_or_b32 v5, v5, v6
    v_pk_add_f32 v[72:73], v[72:73], v[76:77]
    s_waitcnt vmcnt(5)
    v_xor_b32 v6, v2, v82
    v_or_b32 v5, v5, v6
    v_pk_add_f32 v[72:73], v[72:73], v[80:81]
    s_waitcnt vmcnt(4)
    v_xor_b32 v6, v2, v86
    v_or_b32 v5, v5, v6
    v_pk_add_f32 v[72:73], v[72:73], v[84:85]
    s_waitcnt vmcnt(3)
    v_xor_b32 v6, v2, v90
    v_or_b32 v5, v5, v6
    v_pk_add_f32 v[72:73], v[72:73], v[88:89]
    s_waitcnt vmcnt(2)
    v_xor_b32 v6, v2, v94
    v_or_b32 v5, v5, v6
    v_pk_add_f32 v[72:73], v[72:73], v[92:93]
    s_waitcnt vmcnt(1)
    v_xor_b32 v6, v2, v98
    v_or_b32 v5, v5, v6
    v_pk_add_f32 v[72:73], v[72:73], v[96:97]
    s_waitcnt vmcnt(0)
    v_xor_b32 v6, v2, v102
    v_or_b32 v5, v5, v6
    v_pk_add_f32 v[72:73], v[72:73], v[100:101]
    v_cmp_ne_u32 vcc, 0, v5
    s_sub_u32 s99, s99, 1
    s_cbranch_scc1 Lspin_28x
    s_cbranch_vccnz Lspin_28
Lspin_28x:
    v_mov_b64 v[74:75], v[72:73]
    v_mov_b32 v76, 0x2edbe6ff
    s_nop 0
    v_permlane32_swap_b32 v72, v74
    v_permlane32_swap_b32 v73, v75
    v_add_f32 v72, v72, v74
    v_add_f32 v73, v73, v75
    v_mul_f32 v72, 0xbb000000, v72
    v_mul_f32 v73, 0x3b000000, v73
    v_fma_f32 v73, -v72, v72, v73
    v_max_f32 v73, 0, v73
    v_fmac_f32 v76, 0x3f800054, v73
    v_rsq_f32 v74, v76
    s_nop 0
    v_mul_f32 v72, v72, v74
    v_pk_fma_f32 v[32:33], v[16:17], v[74:75], v[72:73] op_sel_hi:[1,0,0]
    v_pk_fma_f32 v[34:35], v[18:19], v[74:75], v[72:73] op_sel_hi:[1,0,0]
    v_cvt_pk_bf16_f32 v48, v32, v33
    v_cvt_pk_bf16_f32 v49, v34, v35
    ds_write_b64 v9, v[48:49] offset:0
    v_pk_fma_f32 v[36:37], v[20:21], v[74:75], v[72:73] op_sel_hi:[1,0,0]
    v_pk_fma_f32 v[38:39], v[22:23], v[74:75], v[72:73] op_sel_hi:[1,0,0]
    v_cvt_pk_bf16_f32 v50, v36, v37
    v_cvt_pk_bf16_f32 v51, v38, v39
    ds_write_b64 v9, v[50:51] offset:16
    v_pk_fma_f32 v[40:41], v[24:25], v[74:75], v[72:73] op_sel_hi:[1,0,0]
    v_pk_fma_f32 v[42:43], v[26:27], v[74:75], v[72:73] op_sel_hi:[1,0,0]
    v_cvt_pk_bf16_f32 v52, v40, v41
    v_cvt_pk_bf16_f32 v53, v42, v43
    ds_write_b64 v9, v[52:53] offset:32
    v_pk_fma_f32 v[44:45], v[28:29], v[74:75], v[72:73] op_sel_hi:[1,0,0]
    v_pk_fma_f32 v[46:47], v[30:31], v[74:75], v[72:73] op_sel_hi:[1,0,0]
    v_cvt_pk_bf16_f32 v54, v44, v45
    v_cvt_pk_bf16_f32 v55, v46, v47
    ds_write_b64 v9, v[54:55] offset:48
    ds_read_b64_tr_b16 v[56:57], v10 offset:0
    ds_read_b64_tr_b16 v[58:59], v10 offset:288
    ds_read_b64_tr_b16 v[60:61], v10 offset:1152
    ds_read_b64_tr_b16 v[62:63], v10 offset:1440
    s_lshl_b32 s50, s47, 1
    s_add_u32 s50, s50, s59
    s_lshl_b32 s50, s50, 6
    s_add_u32 s50, s50, s62
    s_lshl_b32 s51, s50, 11
    s_add_u32 s51, s51, 8388608
    s_waitcnt lgkmcnt(2)
    buffer_store_dwordx4 v[56:59], v1, s[32:35], s51 offen sc1
    s_waitcnt lgkmcnt(0)
    buffer_store_dwordx4 v[60:63], v1, s[32:35], s51 offen offset:1024 sc1
    v_lshrrev_b32 v6, 1, v3
    v_and_b32 v7, 256, v15
    v_lshl_add_u32 v6, v6, 12, v7
    s_lshl_b32 s50, s47, 9
    s_lshl_b32 s51, s46, 2
    s_add_u32 s50, s50, s51
    s_add_u32 s50, s50, 196608
    v_lshlrev_b32 v254, 16, v254
    v_add_f32 v16, v16, v254
    v_add_f32 v17, v17, v254
    v_add_f32 v18, v18, v254
    v_add_f32 v19, v19, v254
    v_add_f32 v20, v20, v254
    v_add_f32 v21, v21, v254
    v_add_f32 v22, v22, v254
    v_add_f32 v23, v23, v254
    v_add_f32 v24, v24, v254
    v_add_f32 v25, v25, v254
    v_add_f32 v26, v26, v254
    v_add_f32 v27, v27, v254
    v_add_f32 v28, v28, v254
    v_add_f32 v29, v29, v254
    v_add_f32 v30, v30, v254
    v_add_f32 v31, v31, v254
    s_waitcnt vmcnt(0)
    s_mov_b64 exec, 1
    ds_add_rtn_u32 v5, v251, v252 offset:52
    s_waitcnt lgkmcnt(0)
    v_cmp_eq_u32 vcc, 3, v5
    s_cbranch_vccz Lpush_29
    s_mov_b32 exec_lo, 0x3fffffff
    buffer_store_dword v2, v6, s[32:35], s50 offen sc1
Lpush_29:
    s_mov_b64 exec, -1
    s_cmp_eq_u32 s48, 15
    s_cbranch_scc1 LA4skip
    s_setprio 0
    buffer_load_dwordx4 v[152:155], v1, s[32:35], s56 offen sc1
    buffer_load_dwordx4 v[156:159], v1, s[32:35], s56 offen offset:1024 sc1
    buffer_load_dwordx4 v[160:163], v1, s[32:35], s56 offen offset:2048 sc1
    s_add_u32 s56, s56, 3072
    buffer_load_dwordx4 v[164:167], v1, s[32:35], s56 offen sc1
    buffer_load_dwordx4 v[168:171], v1, s[32:35], s56 offen offset:1024 sc1
    buffer_load_dwordx4 v[172:175], v1, s[32:35], s56 offen offset:2048 sc1
    s_add_u32 s56, s56, 3072
    buffer_load_dwordx4 v[176:179], v1, s[32:35], s56 offen sc1
    buffer_load_dwordx4 v[180:183], v1, s[32:35], s56 offen offset:1024 sc1
    buffer_load_dwordx4 v[184:187], v1, s[32:35], s56 offen offset:2048 sc1
    s_add_u32 s56, s56, 3072
    buffer_load_dwordx4 v[188:191], v1, s[32:35], s56 offen sc1
    buffer_load_dwordx4 v[192:195], v1, s[32:35], s56 offen offset:1024 sc1
    buffer_load_dwordx4 v[196:199], v1, s[32:35], s56 offen offset:2048 sc1
    s_add_u32 s56, s56, 3072
    buffer_load_dwordx4 v[200:203], v1, s[32:35], s56 offen sc1
    buffer_load_dwordx4 v[204:207], v1, s[32:35], s56 offen offset:1024 sc1
    buffer_load_dwordx4 v[208:211], v1, s[32:35], s56 offen offset:2048 sc1
    s_add_u32 s56, s56, 3072
    buffer_load_dwordx4 v[212:215], v1, s[32:35], s56 offen sc1
    buffer_load_dwordx4 v[216:219], v1, s[32:35], s56 offen offset:1024 sc1
    buffer_load_dwordx4 v[220:223], v1, s[32:35], s56 offen offset:2048 sc1
    s_add_u32 s56, s56, 3072
    buffer_load_dwordx4 v[224:227], v1, s[32:35], s56 offen sc1
    buffer_load_dwordx4 v[228:231], v1, s[32:35], s56 offen offset:1024 sc1
    buffer_load_dwordx4 v[232:235], v1, s[32:35], s56 offen offset:2048 sc1
    s_add_u32 s56, s56, 3072
    buffer_load_dwordx4 v[236:239], v1, s[32:35], s56 offen sc1
    buffer_load_dwordx4 v[240:243], v1, s[32:35], s56 offen offset:1024 sc1
    buffer_load_dwordx4 v[244:247], v1, s[32:35], s56 offen offset:2048 sc1
    s_add_u32 s56, s56, 3072
    s_lshl_b32 s50, s49, 2
    s_add_u32 s50, s50, s45
    s_lshl_b32 s57, s50, 15
    s_add_u32 s57, s57, 8404992
    s_lshl_b32 s53, s45, 5
    s_add_u32 s53, s53, s98
    s_add_u32 s53, s53, 196624
    s_mov_b32 s99, 400000
Lsp_30:
    s_sub_u32 s99, s99, 1
    s_cbranch_scc1 Lsp_30x
    s_buffer_load_dwordx4 s[80:83], s[32:35], s53 glc
    s_waitcnt lgkmcnt(0)
    s_cmp_eq_u64 s[80:81], s[0:1]
    s_cbranch_scc0 Lsp_30
    s_cmp_eq_u64 s[82:83], s[0:1]
    s_cbranch_scc0 Lsp_30
Lsp_30x:
    s_mov_b32 s99, 20000000
Lspin_31:
    s_sleep 1
    ds_read_b32 v5, v251 offset:120
    s_waitcnt lgkmcnt(0)
    v_cmp_gt_u32 vcc, 3, v5
    s_sub_u32 s99, s99, 1
    s_cbranch_scc1 Lspin_31x
    s_cbranch_vccnz Lspin_31
Lspin_31x:
    s_mul_i32 s50, s45, 12288
    v_add_u32 v7, s50, v1
    buffer_load_dwordx4 v[80:83], v1, s[32:35], s57 offen sc1
    buffer_load_dwordx4 v[84:87], v1, s[32:35], s57 offen offset:1024 sc1
    s_add_u32 s57, s57, 2048
    buffer_load_dwordx4 v[88:91], v1, s[32:35], s57 offen sc1
    buffer_load_dwordx4 v[92:95], v1, s[32:35], s57 offen offset:1024 sc1
    s_add_u32 s57, s57, 2048
    buffer_load_dwordx4 v[96:99], v1, s[32:35], s57 offen sc1
    buffer_load_dwordx4 v[100:103], v1, s[32:35], s57 offen offset:1024 sc1
    s_add_u32 s57, s57, 2048
    s_waitcnt vmcnt(5)
    v_mfma_f32_32x32x16_bf16 v[32:47], v[104:107], v[80:83], 0
    buffer_load_dwordx4 v[104:107], v1, s[32:35], s57 offen sc1
    v_mfma_f32_32x32x16_bf16 v[48:63], v[108:111], v[80:83], 0
    buffer_load_dwordx4 v[108:111], v1, s[32:35], s57 offen offset:1024 sc1
    s_add_u32 s57, s57, 2048
    v_mfma_f32_32x32x16_bf16 v[64:79], v[112:115], v[80:83], 0
    buffer_load_dwordx4 v[112:115], v1, s[32:35], s57 offen sc1
    s_waitcnt vmcnt(7)
    v_mfma_f32_32x32x16_bf16 v[32:47], v[116:119], v[84:87], v[32:47]
    buffer_load_dwordx4 v[80:83], v1, s[32:35], s57 offen offset:1024 sc1
    s_add_u32 s57, s57, 2048
    v_mfma_f32_32x32x16_bf16 v[48:63], v[120:123], v[84:87], v[48:63]
    buffer_load_dwordx4 v[116:119], v1, s[32:35], s57 offen sc1
    v_mfma_f32_32x32x16_bf16 v[64:79], v[124:127], v[84:87], v[64:79]
    buffer_load_dwordx4 v[120:123], v1, s[32:35], s57 offen offset:1024 sc1
    s_add_u32 s57, s57, 2048
    s_waitcnt vmcnt(9)
    v_mfma_f32_32x32x16_bf16 v[32:47], v[128:131], v[88:91], v[32:47]
    buffer_load_dwordx4 v[124:127], v1, s[32:35], s56 offen sc1
    v_mfma_f32_32x32x16_bf16 v[48:63], v[132:135], v[88:91], v[48:63]
    buffer_load_dwordx4 v[84:87], v1, s[32:35], s56 offen offset:1024 sc1
    v_mfma_f32_32x32x16_bf16 v[64:79], v[136:139], v[88:91], v[64:79]
    buffer_load_dwordx4 v[128:131], v1, s[32:35], s56 offen offset:2048 sc1
    s_add_u32 s56, s56, 3072
    s_waitcnt vmcnt(11)
    v_mfma_f32_32x32x16_bf16 v[32:47], v[140:143], v[92:95], v[32:47]
    buffer_load_dwordx4 v[132:135], v1, s[32:35], s57 offen sc1
    v_mfma_f32_32x32x16_bf16 v[48:63], v[144:147], v[92:95], v[48:63]
    buffer_load_dwordx4 v[136:139], v1, s[32:35], s56 offen sc1
    v_mfma_f32_32x32x16_bf16 v[64:79], v[148:151], v[92:95], v[64:79]
    buffer_load_dwordx4 v[88:91], v1, s[32:35], s56 offen offset:1024 sc1
    s_waitcnt vmcnt(13)
    v_mfma_f32_32x32x16_bf16 v[32:47], v[152:155], v[96:99], v[32:47]
    buffer_load_dwordx4 v[140:143], v1, s[32:35], s56 offen offset:2048 sc1
    s_add_u32 s56, s56, 3072
    v_mfma_f32_32x32x16_bf16 v[48:63], v[156:159], v[96:99], v[48:63]
    buffer_load_dwordx4 v[144:147], v1, s[32:35], s57 offen offset:1024 sc1
    s_add_u32 s57, s57, 2048
    v_mfma_f32_32x32x16_bf16 v[64:79], v[160:163], v[96:99], v[64:79]
    buffer_load_dwordx4 v[148:151], v1, s[32:35], s56 offen sc1
    s_waitcnt vmcnt(15)
    v_mfma_f32_32x32x16_bf16 v[32:47], v[164:167], v[100:103], v[32:47]
    buffer_load_dwordx4 v[92:95], v1, s[32:35], s56 offen offset:1024 sc1
    v_mfma_f32_32x32x16_bf16 v[48:63], v[168:171], v[100:103], v[48:63]
    buffer_load_dwordx4 v[152:155], v1, s[32:35], s56 offen offset:2048 sc1
    s_add_u32 s56, s56, 3072
    v_mfma_f32_32x32x16_bf16 v[64:79], v[172:175], v[100:103], v[64:79]
    buffer_load_dwordx4 v[156:159], v1, s[32:35], s57 offen sc1
    s_waitcnt vmcnt(17)
    v_mfma_f32_32x32x16_bf16 v[32:47], v[176:179], v[104:107], v[32:47]
    buffer_load_dwordx4 v[160:163], v1, s[32:35], s56 offen sc1
    v_mfma_f32_32x32x16_bf16 v[48:63], v[180:183], v[104:107], v[48:63]
    buffer_load_dwordx4 v[96:99], v1, s[32:35], s56 offen offset:1024 sc1
    v_mfma_f32_32x32x16_bf16 v[64:79], v[184:187], v[104:107], v[64:79]
    buffer_load_dwordx4 v[164:167], v1, s[32:35], s56 offen offset:2048 sc1
    s_add_u32 s56, s56, 3072
    s_waitcnt vmcnt(19)
    v_mfma_f32_32x32x16_bf16 v[32:47], v[188:191], v[108:111], v[32:47]
    buffer_load_dwordx4 v[168:171], v1, s[32:35], s57 offen offset:1024 sc1
    s_add_u32 s57, s57, 2048
    v_mfma_f32_32x32x16_bf16 v[48:63], v[192:195], v[108:111], v[48:63]
    v_mfma_f32_32x32x16_bf16 v[64:79], v[196:199], v[108:111], v[64:79]
    s_waitcnt vmcnt(19)
    v_mfma_f32_32x32x16_bf16 v[32:47], v[200:203], v[112:115], v[32:47]
    v_mfma_f32_32x32x16_bf16 v[48:63], v[204:207], v[112:115], v[48:63]
    v_mfma_f32_32x32x16_bf16 v[64:79], v[208:211], v[112:115], v[64:79]
    s_waitcnt vmcnt(18)
    v_mfma_f32_32x32x16_bf16 v[32:47], v[212:215], v[80:83], v[32:47]
    v_mfma_f32_32x32x16_bf16 v[48:63], v[216:219], v[80:83], v[48:63]
    v_mfma_f32_32x32x16_bf16 v[64:79], v[220:223], v[80:83], v[64:79]
    s_waitcnt vmcnt(17)
    v_mfma_f32_32x32x16_bf16 v[32:47], v[224:227], v[116:119], v[32:47]
    v_mfma_f32_32x32x16_bf16 v[48:63], v[228:231], v[116:119], v[48:63]
    v_mfma_f32_32x32x16_bf16 v[64:79], v[232:235], v[116:119], v[64:79]
    s_waitcnt vmcnt(16)
    v_mfma_f32_32x32x16_bf16 v[32:47], v[236:239], v[120:123], v[32:47]
    v_mfma_f32_32x32x16_bf16 v[48:63], v[240:243], v[120:123], v[48:63]
    v_mfma_f32_32x32x16_bf16 v[64:79], v[244:247], v[120:123], v[64:79]
    s_waitcnt vmcnt(12)
    v_mfma_f32_32x32x16_bf16 v[32:47], v[124:127], v[132:135], v[32:47]
    v_mfma_f32_32x32x16_bf16 v[48:63], v[84:87], v[132:135], v[48:63]
    v_mfma_f32_32x32x16_bf16 v[64:79], v[128:131], v[132:135], v[64:79]
    s_waitcnt vmcnt(8)
    v_mfma_f32_32x32x16_bf16 v[32:47], v[136:139], v[144:147], v[32:47]
    s_waitcnt vmcnt(4)
    v_mfma_f32_32x32x16_bf16 v[32:47], v[148:151], v[156:159], v[32:47]
    s_waitcnt vmcnt(0)
    v_mfma_f32_32x32x16_bf16 v[32:47], v[160:163], v[168:171], v[32:47]
    v_mfma_f32_32x32x16_bf16 v[48:63], v[88:91], v[144:147], v[48:63]
    s_mov_b32 s99, 20000000
Lspin_32:
    ds_read_b32 v5, v251 offset:12
    s_waitcnt lgkmcnt(0)
    v_cmp_gt_u32 vcc, 4, v5
    s_sub_u32 s99, s99, 1
    s_cbranch_scc1 Lspin_32x
    s_cbranch_vccnz Lspin_32
Lspin_32x:
    v_mfma_f32_32x32x16_bf16 v[48:63], v[92:95], v[156:159], v[48:63]
    s_nop 3
    ds_write_b128 v7, v[32:35] offset:0
    ds_write_b128 v7, v[36:39] offset:1024
    v_mfma_f32_32x32x16_bf16 v[48:63], v[96:99], v[168:171], v[48:63]
    ds_write_b128 v7, v[40:43] offset:2048
    ds_write_b128 v7, v[44:47] offset:3072
    v_mfma_f32_32x32x16_bf16 v[64:79], v[140:143], v[144:147], v[64:79]
    v_mfma_f32_32x32x16_bf16 v[64:79], v[152:155], v[156:159], v[64:79]
    s_nop 7
    ds_write_b128 v7, v[48:51] offset:4096
    ds_write_b128 v7, v[52:55] offset:5120
    v_mfma_f32_32x32x16_bf16 v[64:79], v[164:167], v[168:171], v[64:79]
    ds_write_b128 v7, v[56:59] offset:6144
    ds_write_b128 v7, v[60:63] offset:7168
    s_nop 9
    ds_write_b128 v7, v[64:67] offset:8192
    ds_write_b128 v7, v[68:71] offset:9216
    ds_write_b128 v7, v[72:75] offset:10240
    ds_write_b128 v7, v[76:79] offset:11264
LA4skip:
    s_waitcnt lgkmcnt(0)
    s_barrier
    s_lshl_b32 s52, s58, 6
    v_xor_b32 v7, s52, v8
    v_xor_b32 v6, 64, v7
    s_mul_i32 s52, s58, 32768
    s_add_u32 s52, s52, 98304
    v_add_u32 v9, s52, v7
    v_add_u32 v10, s52, v6
    s_mul_i32 s52, s58, 26624
    s_add_u32 s52, s52, 49152
    v_add_u32 v15, s52, v7
    v_add_u32 v247, s52, v6
    s_mov_b32 s99, 20000000
Lspin_33:
    ds_read_b32 v5, v251 offset:24
    s_waitcnt lgkmcnt(0)
    v_cmp_gt_u32 vcc, 4, v5
    s_sub_u32 s99, s99, 1
    s_cbranch_scc1 Lspin_33x
    s_cbranch_vccnz Lspin_33
Lspin_33x:
    ds_read_b64_tr_b16 v[116:117], v10 offset:0
    ds_read_b64_tr_b16 v[118:119], v10 offset:1024
    ds_read_b64_tr_b16 v[112:113], v9 offset:0
    ds_read_b64_tr_b16 v[114:115], v9 offset:1024
    ds_read_b64_tr_b16 v[124:125], v10 offset:2048
    ds_read_b64_tr_b16 v[126:127], v10 offset:3072
    ds_read_b64_tr_b16 v[120:121], v9 offset:2048
    ds_read_b64_tr_b16 v[122:123], v9 offset:3072
    ds_read_b64_tr_b16 v[132:133], v10 offset:4096
    ds_read_b64_tr_b16 v[134:135], v10 offset:5120
    ds_read_b64_tr_b16 v[128:129], v9 offset:4096
    ds_read_b64_tr_b16 v[130:131], v9 offset:5120
    ds_read_b64_tr_b16 v[140:141], v10 offset:6144
    ds_read_b64_tr_b16 v[142:143], v10 offset:7168
    ds_read_b64_tr_b16 v[136:137], v9 offset:6144
    ds_read_b64_tr_b16 v[138:139], v9 offset:7168
    ds_read_b64_tr_b16 v[148:149], v10 offset:8192
    ds_read_b64_tr_b16 v[150:151], v10 offset:9216
    ds_read_b64_tr_b16 v[144:145], v9 offset:8192
    ds_read_b64_tr_b16 v[146:147], v9 offset:9216
    ds_read_b64_tr_b16 v[156:157], v10 offset:10240
    ds_read_b64_tr_b16 v[158:159], v10 offset:11264
    ds_read_b64_tr_b16 v[152:153], v9 offset:10240
    ds_read_b64_tr_b16 v[154:155], v9 offset:11264
    ds_read_b64_tr_b16 v[164:165], v10 offset:12288
    ds_read_b64_tr_b16 v[166:167], v10 offset:13312
    ds_read_b64_tr_b16 v[160:161], v9 offset:12288
    ds_read_b64_tr_b16 v[162:163], v9 offset:13312
    ds_read_b64_tr_b16 v[172:173], v10 offset:14336
    ds_read_b64_tr_b16 v[174:175], v10 offset:15360
    ds_read_b64_tr_b16 v[168:169], v9 offset:14336
    ds_read_b64_tr_b16 v[170:171], v9 offset:15360
    ds_read_b64_tr_b16 v[180:181], v10 offset:16384
    ds_read_b64_tr_b16 v[182:183], v10 offset:17408
    ds_read_b64_tr_b16 v[176:177], v9 offset:16384
    ds_read_b64_tr_b16 v[178:179], v9 offset:17408
    ds_read_b64_tr_b16 v[188:189], v10 offset:18432
    ds_read_b64_tr_b16 v[190:191], v10 offset:19456
    ds_read_b64_tr_b16 v[184:185], v9 offset:18432
    ds_read_b64_tr_b16 v[186:187], v9 offset:19456
    ds_read_b64_tr_b16 v[196:197], v10 offset:20480
    ds_read_b64_tr_b16 v[198:199], v10 offset:21504
    ds_read_b64_tr_b16 v[192:193], v9 offset:20480
    ds_read_b64_tr_b16 v[194:195], v9 offset:21504
    ds_read_b64_tr_b16 v[204:205], v10 offset:22528
    ds_read_b64_tr_b16 v[206:207], v10 offset:23552
    ds_read_b64_tr_b16 v[200:201], v9 offset:22528
    ds_read_b64_tr_b16 v[202:203], v9 offset:23552
    ds_read_b64_tr_b16 v[212:213], v10 offset:24576
    ds_read_b64_tr_b16 v[214:215], v10 offset:25600
    ds_read_b64_tr_b16 v[208:209], v9 offset:24576
    ds_read_b64_tr_b16 v[210:211], v9 offset:25600
    ds_read_b64_tr_b16 v[220:221], v10 offset:26624
    ds_read_b64_tr_b16 v[222:223], v10 offset:27648
    ds_read_b64_tr_b16 v[216:217], v9 offset:26624
    ds_read_b64_tr_b16 v[218:219], v9 offset:27648
    ds_read_b64_tr_b16 v[228:229], v10 offset:28672
    ds_read_b64_tr_b16 v[230:231], v10 offset:29696
    ds_read_b64_tr_b16 v[224:225], v9 offset:28672
    ds_read_b64_tr_b16 v[226:227], v9 offset:29696
    ds_read_b64_tr_b16 v[236:237], v10 offset:30720
    ds_read_b64_tr_b16 v[238:239], v10 offset:31744
    ds_read_b64_tr_b16 v[232:233], v9 offset:30720
    ds_read_b64_tr_b16 v[234:235], v9 offset:31744
    s_waitcnt lgkmcnt(0)
    s_mov_b64 exec, 1
    ds_add_u32 v251, v252 offset:16
    s_mov_b64 exec, -1
    s_mul_i32 s6, s59, 2818048
    s_lshl_b32 s50, s58, 15
    s_add_u32 s6, s6, s50
    s_lshl_b32 s50, s46, 7
    s_add_u32 s6, s6, s50
    v_lshrrev_b32 v6, 3, v3
    v_lshl_add_u32 v6, v6, 12, v253
    s_mov_b32 s99, 20000000
Lspin_34:
    ds_read_b32 v5, v251 offset:16
    s_waitcnt lgkmcnt(0)
    v_cmp_gt_u32 vcc, 4, v5
    s_sub_u32 s99, s99, 1
    s_cbranch_scc1 Lspin_34x
    s_cbranch_vccnz Lspin_34
Lspin_34x:
    s_mul_i32 s51, s59, 32768
    s_lshl_b32 s50, s58, 10
    s_add_u32 s51, s51, s50
    s_add_u32 s51, s51, 98304
    s_and_b32 s52, s47, 3
    s_mul_i32 s52, s52, 8
    s_lshr_b32 s52, s52, 2
    s_mov_b32 s53, 8
Lw2_35:
    s_lshl_b32 s50, s52, 11
    s_add_u32 m0, s50, s51
    s_lshl_b32 s50, s52, 16
    s_add_u32 s50, s50, s6
    s_add_u32 s50, s50, 1769472
    buffer_load_dwordx4 v6, s[24:27], s50 offen lds
    s_add_u32 s52, s52, 1
    s_cmp_eq_u32 s52, 8
    s_cselect_b32 s52, 0, s52
    s_sub_u32 s53, s53, 1
    s_cmp_lg_u32 s53, 0
    s_cbranch_scc1 Lw2_35
    s_setprio 2
    s_lshl_b32 s50, s47, 1
    s_add_u32 s50, s50, s59
    s_mul_i32 s54, s50, 98304
    s_mul_i32 s52, s58, 44032
    s_add_u32 s54, s54, s52
    s_add_u32 s54, s54, 10485760
    s_mov_b32 s92, s54
    s_xor_b32 s50, s45, 1
    s_lshl_b32 s52, s50, 2
    v_add_u32 v13, s52, v251
    s_lshl_b32 s50, s50, 12
    v_add_u32 v11, s50, v1
    s_lshl_b32 s51, s45, 12
    v_add_u32 v12, s51, v1
    s_lshl_b32 s52, s45, 2
    v_add_u32 v14, s52, v251
    s_lshl_b32 s53, s59, 6
    s_mul_i32 s52, s58, 28
    s_add_u32 s53, s53, s52
    s_add_u32 s53, s53, s7
    s_add_u32 s53, s53, 262144
    s_mul_i32 s51, s45, 2560
    v_lshrrev_b32 v240, 6, v250
    v_lshl_add_u32 v240, v240, 4, v250
    v_add_u32 v240, s51, v240
    v_lshrrev_b32 v242, 2, v3
    v_lshl_add_u32 v241, v242, 4, v1
    v_add_u32 v241, s51, v241
    v_and_b32 v6, 0x30, v1
    v_lshl_add_u32 v242, v242, 10, v6
    s_mov_b32 s99, 400000
Lsp_36:
    s_sub_u32 s99, s99, 1
    s_cbranch_scc1 Lsp_36x
    s_buffer_load_dwordx2 s[80:81], s[32:35], s53 glc
    s_waitcnt lgkmcnt(0)
    s_cmp_eq_u64 s[80:81], s[0:1]
    s_cbranch_scc0 Lsp_36
Lsp_36x:
    buffer_load_dwordx4 v[48:51], v1, s[32:35], s54 offen sc1
    buffer_load_dwordx4 v[52:55], v1, s[32:35], s54 offen offset:1024 sc1
    buffer_load_dwordx4 v[56:59], v1, s[32:35], s54 offen offset:2048 sc1
    buffer_load_dwordx4 v[60:63], v1, s[32:35], s54 offen offset:3072 sc1
    s_add_u32 s54, s54, 4096
    buffer_load_dwordx4 v[64:67], v1, s[32:35], s54 offen sc1
    buffer_load_dwordx4 v[68:71], v1, s[32:35], s54 offen offset:1024 sc1
    buffer_load_dwordx4 v[72:75], v1, s[32:35], s54 offen offset:2048 sc1
    buffer_load_dwordx4 v[76:79], v1, s[32:35], s54 offen offset:3072 sc1
    s_add_u32 s54, s54, 4096
    buffer_load_dwordx4 v[80:83], v1, s[32:35], s54 offen sc1
    buffer_load_dwordx4 v[84:87], v1, s[32:35], s54 offen offset:1024 sc1
    buffer_load_dwordx4 v[88:91], v1, s[32:35], s54 offen offset:2048 sc1
    s_mov_b32 s99, 400000
Lsp_37:
    s_sub_u32 s99, s99, 1
    s_cbranch_scc1 Lsp_37x
    s_buffer_load_dwordx8 s[80:87], s[32:35], s53 glc
    s_waitcnt lgkmcnt(0)
    s_cmp_eq_u64 s[80:81], s[0:1]
    s_cbranch_scc0 Lsp_37
    s_cmp_eq_u64 s[82:83], s[0:1]
    s_cbranch_scc0 Lsp_37
    s_cmp_eq_u64 s[84:85], s[0:1]
    s_cbranch_scc0 Lsp_37
    s_cmp_eq_u64 s[86:87], s[0:1]
    s_cbranch_scc0 Lsp_37
Lsp_37x:
    buffer_load_dwordx4 v[92:95], v1, s[32:35], s54 offen offset:3072 sc1
    s_add_u32 s54, s54, 4096
    s_waitcnt vmcnt(11)
    v_mfma_f32_32x32x16_bf16 v[32:47], v[48:51], v[116:119], 0
    v_mfma_f32_32x32x16_bf16 v[16:31], v[48:51], v[112:115], v[16:31]
    buffer_load_dwordx4 v[48:51], v1, s[32:35], s54 offen sc1
    s_waitcnt vmcnt(11)
    v_mfma_f32_32x32x16_bf16 v[32:47], v[52:55], v[124:127], v[32:47]
    v_mfma_f32_32x32x16_bf16 v[16:31], v[52:55], v[120:123], v[16:31]
    buffer_load_dwordx4 v[52:55], v1, s[32:35], s54 offen offset:1024 sc1
    s_mov_b64 exec, 1
    ds_add_u32 v251, v252 offset:20
    s_mov_b64 exec, -1
    s_waitcnt vmcnt(11)
    v_mfma_f32_32x32x16_bf16 v[32:47], v[56:59], v[132:135], v[32:47]
    v_mfma_f32_32x32x16_bf16 v[16:31], v[56:59], v[128:131], v[16:31]
    buffer_load_dwordx4 v[56:59], v1, s[32:35], s54 offen offset:2048 sc1
    s_waitcnt vmcnt(11)
    v_mfma_f32_32x32x16_bf16 v[32:47], v[60:63], v[140:143], v[32:47]
    v_mfma_f32_32x32x16_bf16 v[16:31], v[60:63], v[136:139], v[16:31]
    buffer_load_dwordx4 v[60:63], v1, s[32:35], s54 offen offset:3072 sc1
    s_add_u32 s54, s54, 4096
    s_waitcnt vmcnt(11)
    v_mfma_f32_32x32x16_bf16 v[32:47], v[64:67], v[148:151], v[32:47]
    v_mfma_f32_32x32x16_bf16 v[16:31], v[64:67], v[144:147], v[16:31]
    buffer_load_dwordx4 v[64:67], v1, s[32:35], s54 offen sc1
    s_waitcnt vmcnt(11)
    v_mfma_f32_32x32x16_bf16 v[32:47], v[68:71], v[156:159], v[32:47]
    v_mfma_f32_32x32x16_bf16 v[16:31], v[68:71], v[152:155], v[16:31]
    buffer_load_dwordx4 v[68:71], v1, s[32:35], s54 offen offset:1024 sc1
    s_waitcnt vmcnt(11)
    v_mfma_f32_32x32x16_bf16 v[32:47], v[72:75], v[164:167], v[32:47]
    v_mfma_f32_32x32x16_bf16 v[16:31], v[72:75], v[160:163], v[16:31]
    buffer_load_dwordx4 v[72:75], v1, s[32:35], s54 offen offset:2048 sc1
    s_waitcnt vmcnt(11)
    v_mfma_f32_32x32x16_bf16 v[32:47], v[76:79], v[172:175], v[32:47]
    v_mfma_f32_32x32x16_bf16 v[16:31], v[76:79], v[168:171], v[16:31]
    buffer_load_dwordx4 v[76:79], v1, s[32:35], s54 offen offset:3072 sc1
    s_add_u32 s54, s54, 4096
    s_waitcnt vmcnt(11)
    v_mfma_f32_32x32x16_bf16 v[32:47], v[80:83], v[180:183], v[32:47]
    v_mfma_f32_32x32x16_bf16 v[16:31], v[80:83], v[176:179], v[16:31]
    buffer_load_dwordx4 v[80:83], v1, s[32:35], s54 offen sc1
    s_waitcnt vmcnt(11)
    v_mfma_f32_32x32x16_bf16 v[32:47], v[84:87], v[188:191], v[32:47]
    v_mfma_f32_32x32x16_bf16 v[16:31], v[84:87], v[184:187], v[16:31]
    buffer_load_dwordx4 v[84:87], v1, s[32:35], s54 offen offset:1024 sc1
    s_waitcnt vmcnt(11)
    v_mfma_f32_32x32x16_bf16 v[32:47], v[88:91], v[196:199], v[32:47]
    v_mfma_f32_32x32x16_bf16 v[16:31], v[88:91], v[192:195], v[16:31]
    buffer_load_dwordx4 v[88:91], v1, s[32:35], s54 offen offset:2048 sc1
    s_waitcnt vmcnt(11)
    v_mfma_f32_32x32x16_bf16 v[32:47], v[92:95], v[204:207], v[32:47]
    v_mfma_f32_32x32x16_bf16 v[16:31], v[92:95], v[200:203], v[16:31]
    buffer_load_dwordx4 v[92:95], v1, s[32:35], s54 offen offset:3072 sc1
    s_add_u32 s54, s54, 4096
    s_waitcnt vmcnt(11)
    v_mfma_f32_32x32x16_bf16 v[32:47], v[48:51], v[212:215], v[32:47]
    v_mfma_f32_32x32x16_bf16 v[16:31], v[48:51], v[208:211], v[16:31]
    buffer_load_dwordx4 v[48:51], v1, s[32:35], s54 offen sc1
    s_waitcnt vmcnt(11)
    v_mfma_f32_32x32x16_bf16 v[32:47], v[52:55], v[220:223], v[32:47]
    v_mfma_f32_32x32x16_bf16 v[16:31], v[52:55], v[216:219], v[16:31]
    buffer_load_dwordx4 v[52:55], v1, s[32:35], s54 offen offset:1024 sc1
    s_waitcnt vmcnt(11)
    v_mfma_f32_32x32x16_bf16 v[32:47], v[56:59], v[228:231], v[32:47]
    v_mfma_f32_32x32x16_bf16 v[16:31], v[56:59], v[224:227], v[16:31]
    buffer_load_dwordx4 v[56:59], v1, s[32:35], s54 offen offset:2048 sc1
    s_waitcnt vmcnt(11)
    v_mfma_f32_32x32x16_bf16 v[32:47], v[60:63], v[236:239], v[32:47]
    ds_read_b64_tr_b16 v[100:101], v247 offset:0
    ds_read_b64_tr_b16 v[102:103], v247 offset:1024
    v_mfma_f32_32x32x16_bf16 v[16:31], v[60:63], v[232:235], v[16:31]
    ds_read_b64_tr_b16 v[96:97], v15 offset:0
    ds_read_b64_tr_b16 v[98:99], v15 offset:1024
    buffer_load_dwordx4 v[60:63], v1, s[32:35], s54 offen offset:3072 sc1
    s_add_u32 s54, s54, 4096
    s_waitcnt vmcnt(11) lgkmcnt(2)
    v_mfma_f32_32x32x16_bf16 v[32:47], v[64:67], v[100:103], v[32:47]
    ds_read_b64_tr_b16 v[108:109], v247 offset:2048
    ds_read_b64_tr_b16 v[110:111], v247 offset:3072
    s_waitcnt lgkmcnt(2)
    v_mfma_f32_32x32x16_bf16 v[16:31], v[64:67], v[96:99], v[16:31]
    ds_read_b64_tr_b16 v[104:105], v15 offset:2048
    ds_read_b64_tr_b16 v[106:107], v15 offset:3072
    buffer_load_dwordx4 v[64:67], v1, s[32:35], s54 offen sc1
    s_waitcnt vmcnt(11) lgkmcnt(2)
    v_mfma_f32_32x32x16_bf16 v[32:47], v[68:71], v[108:111], v[32:47]
    ds_read_b64_tr_b16 v[100:101], v247 offset:4096
    ds_read_b64_tr_b16 v[102:103], v247 offset:5120
    s_waitcnt lgkmcnt(2)
    v_mfma_f32_32x32x16_bf16 v[16:31], v[68:71], v[104:107], v[16:31]
    ds_read_b64_tr_b16 v[96:97], v15 offset:4096
    ds_read_b64_tr_b16 v[98:99], v15 offset:5120
    buffer_load_dwordx4 v[68:71], v1, s[32:35], s54 offen offset:1024 sc1
    s_waitcnt vmcnt(11) lgkmcnt(2)
    v_mfma_f32_32x32x16_bf16 v[32:47], v[72:75], v[100:103], v[32:47]
    ds_read_b64_tr_b16 v[108:109], v247 offset:6144
    ds_read_b64_tr_b16 v[110:111], v247 offset:7168
    s_waitcnt lgkmcnt(2)
    v_mfma_f32_32x32x16_bf16 v[16:31], v[72:75], v[96:99], v[16:31]
    ds_read_b64_tr_b16 v[104:105], v15 offset:6144
    ds_read_b64_tr_b16 v[106:107], v15 offset:7168
    buffer_load_dwordx4 v[72:75], v1, s[32:35], s54 offen offset:2048 sc1
    s_waitcnt vmcnt(11) lgkmcnt(2)
    v_mfma_f32_32x32x16_bf16 v[32:47], v[76:79], v[108:111], v[32:47]
    ds_read_b64_tr_b16 v[100:101], v247 offset:8192
    ds_read_b64_tr_b16 v[102:103], v247 offset:9216
    s_waitcnt lgkmcnt(2)
    v_mfma_f32_32x32x16_bf16 v[16:31], v[76:79], v[104:107], v[16:31]
    ds_read_b64_tr_b16 v[96:97], v15 offset:8192
    ds_read_b64_tr_b16 v[98:99], v15 offset:9216
    buffer_load_dwordx4 v[76:79], v1, s[32:35], s54 offen offset:3072 sc1
    s_add_u32 s54, s54, 4096
    s_waitcnt vmcnt(11) lgkmcnt(2)
    v_mfma_f32_32x32x16_bf16 v[32:47], v[80:83], v[100:103], v[32:47]
    ds_read_b64_tr_b16 v[108:109], v247 offset:10240
    ds_read_b64_tr_b16 v[110:111], v247 offset:11264
    s_waitcnt lgkmcnt(2)
    v_mfma_f32_32x32x16_bf16 v[16:31], v[80:83], v[96:99], v[16:31]
    ds_read_b64_tr_b16 v[104:105], v15 offset:10240
    ds_read_b64_tr_b16 v[106:107], v15 offset:11264
    buffer_load_dwordx4 v[80:83], v1, s[32:35], s54 offen sc1
    s_waitcnt vmcnt(11) lgkmcnt(2)
    v_mfma_f32_32x32x16_bf16 v[32:47], v[84:87], v[108:111], v[32:47]
    ds_read_b64_tr_b16 v[100:101], v247 offset:12288
    ds_read_b64_tr_b16 v[102:103], v247 offset:13312
    s_waitcnt lgkmcnt(2)
    v_mfma_f32_32x32x16_bf16 v[16:31], v[84:87], v[104:107], v[16:31]
    ds_read_b64_tr_b16 v[96:97], v15 offset:12288
    ds_read_b64_tr_b16 v[98:99], v15 offset:13312
    buffer_load_dwordx4 v[84:87], v1, s[32:35], s54 offen offset:1024 sc1
    s_waitcnt vmcnt(11) lgkmcnt(2)
    v_mfma_f32_32x32x16_bf16 v[32:47], v[88:91], v[100:103], v[32:47]
    ds_read_b64_tr_b16 v[108:109], v247 offset:14336
    ds_read_b64_tr_b16 v[110:111], v247 offset:15360
    s_waitcnt lgkmcnt(2)
    v_mfma_f32_32x32x16_bf16 v[16:31], v[88:91], v[96:99], v[16:31]
    ds_read_b64_tr_b16 v[104:105], v15 offset:14336
    ds_read_b64_tr_b16 v[106:107], v15 offset:15360
    buffer_load_dwordx4 v[88:91], v1, s[32:35], s54 offen offset:2048 sc1
    ds_read_b32 v5, v251 offset:20
    s_waitcnt vmcnt(11) lgkmcnt(2)
    v_mfma_f32_32x32x16_bf16 v[32:47], v[92:95], v[108:111], v[32:47]
    ds_read_b64_tr_b16 v[100:101], v247 offset:16384
    ds_read_b64_tr_b16 v[102:103], v247 offset:17408
    s_waitcnt lgkmcnt(2)
    v_mfma_f32_32x32x16_bf16 v[16:31], v[92:95], v[104:107], v[16:31]
    ds_read_b64_tr_b16 v[96:97], v15 offset:16384
    ds_read_b64_tr_b16 v[98:99], v15 offset:17408
    buffer_load_dwordx4 v[92:95], v1, s[32:35], s54 offen offset:3072 sc1
    s_add_u32 s54, s54, 4096
    s_waitcnt vmcnt(11) lgkmcnt(2)
    v_mfma_f32_32x32x16_bf16 v[32:47], v[48:51], v[100:103], v[32:47]
    ds_read_b64_tr_b16 v[108:109], v247 offset:18432
    ds_read_b64_tr_b16 v[110:111], v247 offset:19456
    s_waitcnt lgkmcnt(2)
    v_mfma_f32_32x32x16_bf16 v[16:31], v[48:51], v[96:99], v[16:31]
    ds_read_b64_tr_b16 v[104:105], v15 offset:18432
    ds_read_b64_tr_b16 v[106:107], v15 offset:19456
    buffer_load_dwordx4 v[48:51], v1, s[32:35], s54 offen sc1
    v_cmp_gt_u32 vcc, 8, v5
    s_cbranch_vccz LAw2ok
    s_mov_b32 s99, 20000000
Lspin_38:
    ds_read_b32 v5, v251 offset:20
    s_waitcnt lgkmcnt(0)
    v_cmp_gt_u32 vcc, 8, v5
    s_sub_u32 s99, s99, 1
    s_cbranch_scc1 Lspin_38x
    s_cbranch_vccnz Lspin_38
Lspin_38x:
LAw2ok:
    s_waitcnt vmcnt(11) lgkmcnt(2)
    v_mfma_f32_32x32x16_bf16 v[32:47], v[52:55], v[108:111], v[32:47]
    ds_read_b64_tr_b16 v[100:101], v247 offset:20480
    ds_read_b64_tr_b16 v[102:103], v247 offset:21504
    s_waitcnt lgkmcnt(2)
    v_mfma_f32_32x32x16_bf16 v[16:31], v[52:55], v[104:107], v[16:31]
    ds_read_b64_tr_b16 v[96:97], v15 offset:20480
    ds_read_b64_tr_b16 v[98:99], v15 offset:21504
    buffer_load_dwordx4 v[52:55], v1, s[32:35], s54 offen offset:1024 sc1
    s_waitcnt vmcnt(11) lgkmcnt(2)
    v_mfma_f32_32x32x16_bf16 v[32:47], v[56:59], v[100:103], v[32:47]
    ds_read_b64_tr_b16 v[108:109], v10 offset:0
    ds_read_b64_tr_b16 v[110:111], v10 offset:1024
    s_waitcnt lgkmcnt(2)
    v_mfma_f32_32x32x16_bf16 v[16:31], v[56:59], v[96:99], v[16:31]
    ds_read_b64_tr_b16 v[104:105], v9 offset:0
    ds_read_b64_tr_b16 v[106:107], v9 offset:1024
    buffer_load_dwordx4 v[56:59], v1, s[32:35], s54 offen offset:2048 sc1
    s_waitcnt vmcnt(11) lgkmcnt(2)
    v_mfma_f32_32x32x16_bf16 v[32:47], v[60:63], v[108:111], v[32:47]
    ds_read_b64_tr_b16 v[100:101], v10 offset:2048
    ds_read_b64_tr_b16 v[102:103], v10 offset:3072
    s_waitcnt lgkmcnt(2)
    v_mfma_f32_32x32x16_bf16 v[16:31], v[60:63], v[104:107], v[16:31]
    ds_read_b64_tr_b16 v[96:97], v9 offset:2048
    ds_read_b64_tr_b16 v[98:99], v9 offset:3072
    buffer_load_dwordx4 v[60:63], v1, s[32:35], s54 offen offset:3072 sc1
    s_add_u32 s54, s54, 4096
    s_waitcnt vmcnt(11) lgkmcnt(2)
    v_mfma_f32_32x32x16_bf16 v[32:47], v[64:67], v[100:103], v[32:47]
    ds_read_b64_tr_b16 v[108:109], v10 offset:4096
    ds_read_b64_tr_b16 v[110:111], v10 offset:5120
    s_waitcnt lgkmcnt(2)
    v_mfma_f32_32x32x16_bf16 v[16:31], v[64:67], v[96:99], v[16:31]
    ds_read_b64_tr_b16 v[104:105], v9 offset:4096
    ds_read_b64_tr_b16 v[106:107], v9 offset:5120
    buffer_load_dwordx4 v[64:67], v1, s[32:35], s54 offen sc1
    s_waitcnt vmcnt(11) lgkmcnt(2)
    v_mfma_f32_32x32x16_bf16 v[32:47], v[68:71], v[108:111], v[32:47]
    ds_read_b64_tr_b16 v[100:101], v10 offset:6144
    ds_read_b64_tr_b16 v[102:103], v10 offset:7168
    s_waitcnt lgkmcnt(2)
    v_mfma_f32_32x32x16_bf16 v[16:31], v[68:71], v[104:107], v[16:31]
    ds_read_b64_tr_b16 v[96:97], v9 offset:6144
    ds_read_b64_tr_b16 v[98:99], v9 offset:7168
    buffer_load_dwordx4 v[68:71], v1, s[32:35], s54 offen offset:1024 sc1
    s_waitcnt vmcnt(11) lgkmcnt(2)
    v_mfma_f32_32x32x16_bf16 v[32:47], v[72:75], v[100:103], v[32:47]
    ds_read_b64_tr_b16 v[108:109], v10 offset:8192
    ds_read_b64_tr_b16 v[110:111], v10 offset:9216
    s_waitcnt lgkmcnt(2)
    v_mfma_f32_32x32x16_bf16 v[16:31], v[72:75], v[96:99], v[16:31]
    ds_read_b64_tr_b16 v[104:105], v9 offset:8192
    ds_read_b64_tr_b16 v[106:107], v9 offset:9216
    buffer_load_dwordx4 v[72:75], v1, s[32:35], s54 offen offset:2048 sc1
    s_waitcnt vmcnt(11) lgkmcnt(2)
    v_mfma_f32_32x32x16_bf16 v[32:47], v[76:79], v[108:111], v[32:47]
    ds_read_b64_tr_b16 v[100:101], v10 offset:10240
    ds_read_b64_tr_b16 v[102:103], v10 offset:11264
    s_waitcnt lgkmcnt(2)
    v_mfma_f32_32x32x16_bf16 v[16:31], v[76:79], v[104:107], v[16:31]
    ds_read_b64_tr_b16 v[96:97], v9 offset:10240
    ds_read_b64_tr_b16 v[98:99], v9 offset:11264
    s_waitcnt vmcnt(10) lgkmcnt(2)
    v_mfma_f32_32x32x16_bf16 v[32:47], v[80:83], v[100:103], v[32:47]
    ds_read_b64_tr_b16 v[108:109], v10 offset:12288
    ds_read_b64_tr_b16 v[110:111], v10 offset:13312
    s_waitcnt lgkmcnt(2)
    v_mfma_f32_32x32x16_bf16 v[16:31], v[80:83], v[96:99], v[16:31]
    ds_read_b64_tr_b16 v[104:105], v9 offset:12288
    ds_read_b64_tr_b16 v[106:107], v9 offset:13312
    s_waitcnt vmcnt(9) lgkmcnt(2)
    v_mfma_f32_32x32x16_bf16 v[32:47], v[84:87], v[108:111], v[32:47]
    ds_read_b64_tr_b16 v[100:101], v10 offset:14336
    ds_read_b64_tr_b16 v[102:103], v10 offset:15360
    s_waitcnt lgkmcnt(2)
    v_mfma_f32_32x32x16_bf16 v[16:31], v[84:87], v[104:107], v[16:31]
    ds_read_b64_tr_b16 v[96:97], v9 offset:14336
    ds_read_b64_tr_b16 v[98:99], v9 offset:15360
    s_waitcnt vmcnt(8) lgkmcnt(2)
    v_mfma_f32_32x32x16_bf16 v[32:47], v[88:91], v[100:103], v[32:47]
    ds_read_b64_tr_b16 v[108:109], v10 offset:16384
    ds_read_b64_tr_b16 v[110:111], v10 offset:17408
    s_waitcnt lgkmcnt(2)
    v_mfma_f32_32x32x16_bf16 v[16:31], v[88:91], v[96:99], v[16:31]
    ds_read_b64_tr_b16 v[104:105], v9 offset:16384
    ds_read_b64_tr_b16 v[106:107], v9 offset:17408
    s_waitcnt vmcnt(7) lgkmcnt(2)
    v_mfma_f32_32x32x16_bf16 v[32:47], v[92:95], v[108:111], v[32:47]
    ds_read_b64_tr_b16 v[100:101], v10 offset:18432
    ds_read_b64_tr_b16 v[102:103], v10 offset:19456
    s_waitcnt lgkmcnt(2)
    v_mfma_f32_32x32x16_bf16 v[16:31], v[92:95], v[104:107], v[16:31]
    ds_read_b64_tr_b16 v[96:97], v9 offset:18432
    ds_read_b64_tr_b16 v[98:99], v9 offset:19456
    s_waitcnt vmcnt(6) lgkmcnt(2)
    v_mfma_f32_32x32x16_bf16 v[32:47], v[48:51], v[100:103], v[32:47]
    ds_read_b64_tr_b16 v[108:109], v10 offset:20480
    ds_read_b64_tr_b16 v[110:111], v10 offset:21504
    s_waitcnt lgkmcnt(2)
    v_mfma_f32_32x32x16_bf16 v[16:31], v[48:51], v[96:99], v[16:31]
    ds_read_b64_tr_b16 v[104:105], v9 offset:20480
    ds_read_b64_tr_b16 v[106:107], v9 offset:21504
    s_waitcnt vmcnt(5) lgkmcnt(2)
    v_mfma_f32_32x32x16_bf16 v[32:47], v[52:55], v[108:111], v[32:47]
    ds_read_b64_tr_b16 v[100:101], v10 offset:22528
    ds_read_b64_tr_b16 v[102:103], v10 offset:23552
    s_waitcnt lgkmcnt(2)
    v_mfma_f32_32x32x16_bf16 v[16:31], v[52:55], v[104:107], v[16:31]
    ds_read_b64_tr_b16 v[96:97], v9 offset:22528
    ds_read_b64_tr_b16 v[98:99], v9 offset:23552
    s_waitcnt vmcnt(4) lgkmcnt(2)
    v_mfma_f32_32x32x16_bf16 v[32:47], v[56:59], v[100:103], v[32:47]
    ds_read_b64_tr_b16 v[116:117], v10 offset:24576
    ds_read_b64_tr_b16 v[118:119], v10 offset:25600
    s_waitcnt lgkmcnt(2)
    v_mfma_f32_32x32x16_bf16 v[16:31], v[56:59], v[96:99], v[16:31]
    ds_read_b64_tr_b16 v[112:113], v9 offset:24576
    ds_read_b64_tr_b16 v[114:115], v9 offset:25600
    s_waitcnt vmcnt(3) lgkmcnt(2)
    v_mfma_f32_32x32x16_bf16 v[32:47], v[60:63], v[116:119], v[32:47]
    ds_read_b64_tr_b16 v[124:125], v10 offset:26624
    ds_read_b64_tr_b16 v[126:127], v10 offset:27648
    s_waitcnt lgkmcnt(2)
    ds_read_b64_tr_b16 v[120:121], v9 offset:26624
    ds_read_b64_tr_b16 v[122:123], v9 offset:27648
    s_waitcnt vmcnt(2) lgkmcnt(2)
    v_mfma_f32_32x32x16_bf16 v[32:47], v[64:67], v[124:127], v[32:47]
    ds_read_b64_tr_b16 v[132:133], v10 offset:28672
    ds_read_b64_tr_b16 v[134:135], v10 offset:29696
    s_waitcnt lgkmcnt(2)
    ds_read_b64_tr_b16 v[128:129], v9 offset:28672
    ds_read_b64_tr_b16 v[130:131], v9 offset:29696
    s_waitcnt vmcnt(1) lgkmcnt(2)
    v_mfma_f32_32x32x16_bf16 v[32:47], v[68:71], v[132:135], v[32:47]
    ds_read_b64_tr_b16 v[140:141], v10 offset:30720
    ds_read_b64_tr_b16 v[142:143], v10 offset:31744
    s_waitcnt lgkmcnt(2)
    ds_read_b64_tr_b16 v[136:137], v9 offset:30720
    ds_read_b64_tr_b16 v[138:139], v9 offset:31744
    s_waitcnt vmcnt(0) lgkmcnt(2)
    v_mfma_f32_32x32x16_bf16 v[32:47], v[72:75], v[140:143], v[32:47]
    s_waitcnt lgkmcnt(0)
    s_add_u32 s54, s61, 16384
    v_mfma_f32_32x32x16_bf16 v[16:31], v[60:63], v[112:115], v[16:31]
    v_mfma_f32_32x32x16_bf16 v[16:31], v[64:67], v[120:123], v[16:31]
    s_nop 7
    ds_write_b128 v11, v[32:35] offset:0
    ds_write_b128 v11, v[36:39] offset:1024
    v_mfma_f32_32x32x16_bf16 v[16:31], v[68:71], v[128:131], v[16:31]
    ds_write_b128 v11, v[40:43] offset:2048
    ds_write_b128 v11, v[44:47] offset:3072
    v_mfma_f32_32x32x16_bf16 v[16:31], v[72:75], v[136:139], v[16:31]
    s_mov_b64 exec, 1
    ds_add_u32 v13, v252 offset:80
    s_mov_b64 exec, -1
    s_mov_b32 s99, 20000000
Lspin_39:
    ds_read_b32 v5, v14 offset:80
    s_waitcnt lgkmcnt(0)
    v_cmp_gt_u32 vcc, 1, v5
    s_sub_u32 s99, s99, 1
    s_cbranch_scc1 Lspin_39x
    s_cbranch_vccnz Lspin_39
Lspin_39x:
    ds_read_b128 v[160:163], v12 offset:0
    ds_read_b128 v[164:167], v12 offset:1024
    ds_read_b128 v[168:171], v12 offset:2048
    ds_read_b128 v[172:175], v12 offset:3072
    s_waitcnt lgkmcnt(3)
    v_pk_add_f32 v[16:17], v[16:17], v[160:161]
    v_pk_add_f32 v[18:19], v[18:19], v[162:163]
    v_cvt_pk_bf16_f32 v64, v16, v17
    v_cvt_pk_bf16_f32 v65, v18, v19
    ds_write_b64 v240, v[64:65] offset:16384
    s_waitcnt lgkmcnt(3)
    v_pk_add_f32 v[20:21], v[20:21], v[164:165]
    v_pk_add_f32 v[22:23], v[22:23], v[166:167]
    v_cvt_pk_bf16_f32 v66, v20, v21
    v_cvt_pk_bf16_f32 v67, v22, v23
    ds_write_b64 v240, v[66:67] offset:16400
    s_waitcnt lgkmcnt(3)
    v_pk_add_f32 v[24:25], v[24:25], v[168:169]
    v_pk_add_f32 v[26:27], v[26:27], v[170:171]
    v_cvt_pk_bf16_f32 v68, v24, v25
    v_cvt_pk_bf16_f32 v69, v26, v27
    ds_write_b64 v240, v[68:69] offset:16416
    s_waitcnt lgkmcnt(3)
    v_pk_add_f32 v[28:29], v[28:29], v[172:173]
    v_pk_add_f32 v[30:31], v[30:31], v[174:175]
    v_cvt_pk_bf16_f32 v70, v28, v29
    v_cvt_pk_bf16_f32 v71, v30, v31
    ds_write_b64 v240, v[70:71] offset:16432
    ds_read_b128 v[72:75], v241 offset:16384
    ds_read_b128 v[76:79], v241 offset:17664
    s_waitcnt lgkmcnt(1)
    buffer_store_dwordx4 v[72:75], v242, s[28:31], s61 offen sc1
    s_waitcnt lgkmcnt(0)
    buffer_store_dwordx4 v[76:79], v242, s[28:31], s54 offen sc1
    s_or_b32 s50, s2, s45
    s_cmp_lg_u32 s50, 0
    s_cbranch_scc1 Lnoep
    s_mov_b64 exec, 1
    buffer_store_dword v2, v4, s[32:35], 0 offen
    s_mov_b64 exec, -1
Lnoep:
    s_endpgm
Lfallback:
    s_cmp_lg_u32 s55, 0
    s_cbranch_scc1 Lfbret
    s_mov_b32 s55, 1
    s_cmp_eq_u32 s56, 0
    s_cbranch_scc1 Lfbret
    v_add_u32 v211, s57, v208
    s_cmp_lt_u32 s46, 4
    s_cselect_b64 vcc, -1, 0
    v_cndmask_b32 v6, v221, 0, vcc
    v_cndmask_b32 v112, 0, v6, s[64:65]
    v_cndmask_b32 v113, 0, v6, s[66:67]
    v_cndmask_b32 v114, 0, v6, s[68:69]
    v_cndmask_b32 v115, 0, v6, s[70:71]
    v_cndmask_b32 v116, 0, v6, s[72:73]
    v_cndmask_b32 v117, 0, v6, s[74:75]
    v_cndmask_b32 v118, 0, v6, s[76:77]
    v_cndmask_b32 v119, 0, v6, s[78:79]
    v_cndmask_b32 v120, 0, v6, s[80:81]
    v_cndmask_b32 v121, 0, v6, s[82:83]
    v_cndmask_b32 v122, 0, v6, s[84:85]
    v_cndmask_b32 v123, 0, v6, s[86:87]
    v_cndmask_b32 v124, 0, v6, s[88:89]
    v_cndmask_b32 v125, 0, v6, s[90:91]
    v_cndmask_b32 v126, 0, v6, s[92:93]
    v_cndmask_b32 v127, 0, v6, s[94:95]
    s_mov_b32 s50, s56
Lfb1:
    ds_read_b128 v[144:147], v211 offset:16512
    ds_read_b128 v[148:151], v211 offset:17536
    s_waitcnt lgkmcnt(0)
    v_mfma_f32_32x32x16_bf16 v[16:31], v[144:147], v[8:11], v[112:127]
    v_mfma_f32_32x32x16_bf16 v[32:47], v[148:151], v[12:15], v[112:127]
    v_subrev_u32 v211, 8256, v211
    s_nop 9
    v_max3_f32 v212, v16, v17, v212
    v_max3_f32 v212, v18, v19, v212
    v_max3_f32 v212, v20, v21, v212
    v_max3_f32 v212, v22, v23, v212
    v_max3_f32 v212, v24, v25, v212
    v_max3_f32 v212, v26, v27, v212
    v_max3_f32 v212, v28, v29, v212
    v_max3_f32 v212, v30, v31, v212
    v_max3_f32 v214, v32, v33, v214
    v_max3_f32 v214, v34, v35, v214
    v_max3_f32 v214, v36, v37, v214
    v_max3_f32 v214, v38, v39, v214
    v_max3_f32 v214, v40, v41, v214
    v_max3_f32 v214, v42, v43, v214
    v_max3_f32 v214, v44, v45, v214
    v_max3_f32 v214, v46, v47, v214
    v_mov_b64 v[112:113], 0
    v_mov_b64 v[114:115], 0
    v_mov_b64 v[116:117], 0
    v_mov_b64 v[118:119], 0
    v_mov_b64 v[120:121], 0
    v_mov_b64 v[122:123], 0
    v_mov_b64 v[124:125], 0
    v_mov_b64 v[126:127], 0
    s_sub_u32 s50, s50, 1
    s_cmp_lg_u32 s50, 0
    s_cbranch_scc1 Lfb1
    s_branch LE1
Lcodeend:
.section .rodata,"a"
.p2align 6
.amdhsa_kernel sequential_preLN__sliding_block__mixer_token_mlp__prompt_kernel
  .amdhsa_next_free_vgpr 256
  .amdhsa_next_free_sgpr 102
  .amdhsa_accum_offset 256
  .amdhsa_group_segment_fixed_size 0
  .amdhsa_kernarg_size 88
  .amdhsa_user_sgpr_count 2
  .amdhsa_user_sgpr_kernarg_segment_ptr 1
  .amdhsa_system_sgpr_workgroup_id_x 1
.end_amdhsa_kernel
```
